```python
import torch

def _softmax(x, axis=-1):
    return torch.softmax(x, dim=axis)
def _gelu(x):
    return torch.nn.functional.gelu(x, approximate="tanh")
def _silu(x):
    return torch.nn.functional.silu(x)
def _sigmoid(x):
    return torch.sigmoid(x)
def _layernorm(x, axis=-1, eps=1e-5):
    m = x.mean(dim=axis, keepdim=True)
    v = x.var(dim=axis, keepdim=True, unbiased=False)
    return (x - m) / torch.sqrt(v + eps)
def _scatter_add(tgt, idx, src, axis=0):
    return tgt.clone().index_add_(axis, idx, src)
def _segment_sum(src, seg, n):
    out = torch.zeros((n,) + src.shape[1:], dtype=src.dtype)
    return out.index_add_(0, seg, src)
def _pad(x, pw):
    flat = tuple(v for pair in reversed(pw) for v in pair)
    return torch.nn.functional.pad(x, flat)

kernel_name = 'recurrent_scan__linear_attn_block__mixer_token_mlp__prompt'

def setup_inputs():

    _w = (lambda a: (lambda t: t.to(torch.bfloat16) if t.is_floating_point() else t)(torch.as_tensor(a)))
    def _A_setup():
        B, S, D = 1, 2048, 512
        return {
            "x": _w((lambda *s: torch.randn(*s, dtype=torch.bfloat16) * 0.05)(B, S, D)),
            "wqkv": _w((lambda *s: torch.randn(*s, dtype=torch.bfloat16) * 0.2)(D, 3 * D)),
            "wo": _w((lambda *s: torch.randn(*s, dtype=torch.bfloat16) * 0.2)(D, D)),
        }
    _A_in = _A_setup()

    def _B_setup():
        B, S, D, F = 1, 2048, 512, 1792
        return {
            "x": _w((lambda *s: torch.randn(*s, dtype=torch.bfloat16) * 0.05)(B, S, D)),
            "w1": _w((lambda *s: torch.randn(*s, dtype=torch.bfloat16) * 0.4)(S, F) * (S ** -0.5)),
            "b1": _w((lambda *s: torch.randn(*s, dtype=torch.bfloat16) * 3.2)(F) * 0.02),
            "w2": _w((lambda *s: torch.randn(*s, dtype=torch.bfloat16) * 0.1)(F, S) * (F ** -0.5)),
            "b2": _w((lambda *s: torch.randn(*s, dtype=torch.bfloat16) * 0.2)(S) * 0.02),
        }
    _B_in = _B_setup()

    return {
        "A_x": _A_in["x"],
        "A_wqkv": _A_in["wqkv"],
        "A_wo": _A_in["wo"],
        "B_x": _B_in["x"],
        "B_w1": _B_in["w1"],
        "B_b1": _B_in["b1"],
        "B_w2": _B_in["w2"],
        "B_b2": _B_in["b2"],
    }

def reference(A_x, A_wqkv, A_wo, B_x, B_w1, B_b1, B_w2, B_b2):
    def _A_ref(x, wqkv, wo):
        B, S, D = x.shape
        H = 32; Dh = D // H
        qkv = (lambda x, *d: x.permute(*d))((x @ wqkv).reshape(B, S, 3, H, Dh), 2, 0, 3, 1, 4)
        q, k, v = qkv[0], qkv[1], qkv[2]
        phi = lambda t: torch.where(t > 0, t + 1, torch.exp(t)) + 1e-6
        pq, pk = phi(q), phi(k)
        kv = torch.einsum("bhsd,bhse->bhde", pk, v)
        z = torch.einsum("bhsd->bhd", pk)
        num = torch.einsum("bhqd,bhde->bhqe", pq, kv)
        den = torch.einsum("bhqd,bhd->bhq", pq, z)[..., None] + 1e-6
        o = num / den
        return (lambda x, *d: x.permute(*d))(o, 0, 2, 1, 3).reshape(B, S, D) @ wo

    def _B_ref(x, w1, b1, w2, b2):
        B, S, D = x.shape
        h = _layernorm(x, axis=-1)
        u = torch.einsum("bsd,sf->bdf", h, w1) + b1
        u = _gelu(u)
        y = torch.einsum("bdf,fs->bds", u, w2) + b2
        return (lambda x, *d: x.permute(*d))(y, 0, 2, 1)

    x = A_x
    xn = _layernorm(x, axis=-1)
    s = _A_ref(xn, A_wqkv, A_wo)
    g = _silu(_B_ref(xn, B_w1, B_b1, B_w2, B_b2))
    return x + s * g
```

```asm
; @launch grid=(256,1,1) block=(256,1,1) lds=163840
.amdgcn_target "amdgcn-amd-amdhsa--gfx950"
.text
.globl recurrent_scan__linear_attn_block__mixer_token_mlp__prompt_kernel
.p2align 12
.p2align 8
.type recurrent_scan__linear_attn_block__mixer_token_mlp__prompt_kernel,@function
recurrent_scan__linear_attn_block__mixer_token_mlp__prompt_kernel:
    s_cmp_ge_u32 s2, 256
    s_cbranch_scc1 L_end
    s_load_dwordx2 s[8:9], s[0:1], 0
    s_load_dwordx2 s[12:13], s[0:1], 8
    s_load_dwordx2 s[28:29], s[0:1], 80
    s_load_dwordx16 s[48:63], s[0:1], 16
    s_getpc_b64 s[100:101]
L_pc:
    s_lshr_b32 s4, s2, 3
    s_lshl_b32 s4, s4, 7
    v_lshrrev_b32 v16, 4, v0
    v_lshl_add_u32 v16, v16, 12, s4
    v_min_u32 v16, L_end-L_pc, v16
    global_load_dword v251, v16, s[100:101]
    v_lshrrev_b32 v1, 6, v0
    v_and_b32 v0, 63, v0
    v_readfirstlane_b32 s3, v1
    s_mov_b32 s10, 0x200000
    s_mov_b32 s11, 0x20000
    s_mov_b32 s14, 0x180000
    s_mov_b32 s15, 0x20000
    s_mov_b32 s18, 0x80000
    s_mov_b32 s19, 0x20000
    s_mov_b32 s22, 0x700000
    s_mov_b32 s23, 0x20000
    s_mov_b32 s38, 0xe00
    s_mov_b32 s39, 0x20000
    s_mov_b32 s26, 0x700000
    s_mov_b32 s27, 0x20000
    s_mov_b32 s42, 0x1000
    s_mov_b32 s43, 0x20000
    s_mov_b32 s34, 0x200000
    s_mov_b32 s35, 0x20000
    s_mov_b32 s30, 0xb00000
    s_mov_b32 s31, 0x20000
    s_and_b32 s65, s2, 7
    s_lshr_b32 s66, s2, 3
    v_lshlrev_b32 v1, 4, v0
    s_and_b32 s6, s65, 3
    s_lshl_b32 s4, s6, 3
    s_and_b32 s7, s66, 7
    s_add_u32 s44, s4, s7
    s_and_b32 s5, s65, 4
    s_lshr_b32 s7, s66, 3
    s_add_u32 s45, s5, s7
    s_sub_u32 s4, s44, s45
    s_and_b32 s4, s4, 3
    s_mov_b32 s71, 0x76534210
    s_cmp_eq_u32 s4, 1
    s_cselect_b32 s71, 0x76453201, s71
    s_cmp_eq_u32 s4, 2
    s_cselect_b32 s71, 0x75643120, s71
    s_cmp_eq_u32 s4, 3
    s_cselect_b32 s71, 0x67542310, s71
    s_lshl_b32 s6, s6, 1
    s_xor_b32 s6, s6, s5
    s_mul_i32 s6, s6, 0x11111111
    s_xor_b32 s71, s71, s6
    s_mov_b32 s85, s45
    s_sub_u32 s4, s45, s85
    s_lshl_b32 s4, s4, 7
    s_add_u32 s90, s4, 1024
    s_lshl_b32 s72, s85, 7
    s_lshl_b32 s73, s44, 16
    s_lshl_b32 s77, s3, 11
    s_lshl_b32 s78, s3, 12
    v_lshrrev_b32 v16, 3, v0
    v_and_b32 v17, 7, v0
    s_lshl_b32 s4, s3, 4
    v_add_u32 v18, s4, v16
    v_and_b32 v19, 2, v16
    v_xor_b32 v19, v19, v17
    v_lshlrev_b32 v19, 4, v19
    v_mul_u32_u24 v92, 3072, v18
    v_add_u32 v2, v92, v19
    v_xor_b32 v19, 64, v19
    v_add_u32 v92, 23552, v92
    v_add_u32 v3, v92, v19
    v_lshrrev_b32 v19, 1, v16
    v_xor_b32 v19, v19, v17
    v_lshlrev_b32 v19, 4, v19
    v_lshl_add_u32 v4, v18, 10, v19
    v_xor_b32 v19, 64, v4
    v_add_u32 v5, 7168, v19
    s_lshl_b32 s5, s45, 13
    s_add_u32 s4, s73, s5
    s_add_u32 s4, s4, s77
    s_waitcnt lgkmcnt(0)
    buffer_load_dwordx4 v[96:99], v1, s[8:11], s4 offen
    buffer_load_dwordx4 v[100:103], v1, s[8:11], s4 offen offset:1024
    s_add_u32 s6, s28, 9957376
    s_addc_u32 s7, s29, 0
    s_load_dword s64, s[6:7], 0
    s_add_u32 s6, s28, 11530240
    s_addc_u32 s7, s29, 0
    s_load_dword s91, s[6:7], 0
    s_add_u32 m0, s77, 0
    s_bfe_u32 s76, s71, 0x40000
    s_mul_i32 s74, s76, 196608
    s_add_u32 s74, s74, s72
    buffer_load_dwordx4 v2, s[12:15], s74 offen lds
    buffer_load_dwordx4 v3, s[12:15], s74 offen offset:1024 lds
    s_add_u32 m0, s77, 8192
    s_add_u32 s74, s74, s90
    buffer_load_dwordx4 v2, s[12:15], s74 offen lds
    buffer_load_dwordx4 v3, s[12:15], s74 offen offset:1024 lds
    s_add_u32 m0, s77, 16384
    s_add_u32 s74, s74, 1024
    buffer_load_dwordx4 v2, s[12:15], s74 offen lds
    buffer_load_dwordx4 v3, s[12:15], s74 offen offset:1024 lds
    s_add_u32 m0, s77, 24576
    s_lshl_b32 s75, s76, 7
    s_add_u32 s75, s75, s73
    buffer_load_dwordx4 v4, s[8:11], s75 offen lds
    buffer_load_dwordx4 v5, s[8:11], s75 offen offset:1024 lds
    s_mov_b64 s[16:17], s[48:49]
    s_mov_b64 s[20:21], s[52:53]
    s_mov_b64 s[36:37], s[54:55]
    s_mov_b64 s[24:25], s[56:57]
    s_mov_b64 s[40:41], s[58:59]
    s_mov_b64 s[32:33], s[60:61]
    v_and_b32 v16, 15, v0
    v_lshrrev_b32 v17, 4, v0
    v_lshrrev_b32 v18, 1, v16
    v_xor_b32 v18, v18, v17
    v_lshlrev_b32 v18, 4, v18
    v_lshl_add_u32 v18, v16, 7, v18
    v_add_u32 v6, 24576, v18
    v_xor_b32 v7, 64, v6
    v_add_u32 v8, 0x10000, v6
    v_add_u32 v9, 0x10000, v7
    v_add_u32 v10, s77, v6
    v_add_u32 v11, s77, v7
    v_add_u32 v12, s77, v8
    v_add_u32 v13, s77, v9
    v_lshrrev_b32 v18, 2, v16
    v_and_b32 v19, 3, v16
    v_lshrrev_b32 v92, 1, v18
    v_and_b32 v93, 1, v17
    v_lshl_add_u32 v92, v93, 1, v92
    v_xor_b32 v92, s3, v92
    v_lshlrev_b32 v92, 5, v92
    v_lshl_add_u32 v92, v19, 3, v92
    v_lshl_add_u32 v93, v17, 3, v18
    v_lshl_add_u32 v14, v93, 7, v92
    v_add_u32 v15, 0x10000, v14
    v_lshlrev_b32 v94, 10, v18
    v_lshl_add_u32 v94, v17, 5, v94
    v_lshl_add_u32 v94, v19, 3, v94
    s_lshl_b32 s4, s3, 8
    s_add_u32 s4, s4, 131072
    v_add_u32 v94, s4, v94
    v_lshrrev_b32 v95, 5, v0
    v_lshlrev_b32 v95, 17, v95
    v_lshl_add_u32 v95, v16, 4, v95
    v_and_b32 v16, 16, v0
    v_lshl_add_u32 v95, v16, 6, v95
    v_mov_b32 v20, 0x3f803f80
    v_mov_b32 v21, 0x3f803f80
    v_mov_b32 v22, 0x3f803f80
    v_mov_b32 v23, 0x3f803f80
    v_lshrrev_b32 v16, 4, v0
    v_xnor_b32 v16, v16, v0
    v_bfe_i32 v16, v16, 1, 1
    v_and_b32 v80, v20, v16
    v_and_b32 v81, v20, v16
    v_and_b32 v82, v20, v16
    v_and_b32 v83, v20, v16
    v_bfe_i32 v16, v0, 0, 1
    v_and_b32 v16, 0xaaaaaaaa, v16
    v_or_b32 v72, 0x44444444, v16
    v_mov_b32 v88, 0
    v_mov_b32 v76, 0
    v_mov_b32 v89, 0
    v_mov_b32 v77, 0
    v_mov_b32 v90, 0
    v_mov_b32 v78, 0
    v_mov_b32 v91, 0
    v_mov_b32 v79, 0
    s_add_u32 m0, s77, 32768
    s_bfe_u32 s76, s71, 0x40004
    s_mul_i32 s74, s76, 196608
    s_add_u32 s74, s74, s72
    buffer_load_dwordx4 v2, s[12:15], s74 offen lds
    buffer_load_dwordx4 v3, s[12:15], s74 offen offset:1024 lds
    s_mov_b64 exec, 0
    s_cmp_eq_u32 s3, 0
    s_cbranch_scc1 L_w1
    s_cmp_eq_u32 s3, 1
    s_cbranch_scc1 L_w2
    s_cmp_eq_u32 s3, 2
    s_cbranch_scc1 L_w3
    s_branch L_w4
L_wret:
    s_mov_b64 exec, -1
    s_waitcnt vmcnt(10)
    v_dot2_f32_bf16 v120, v96, v20, 0
    v_dot2_f32_bf16 v121, v96, v96, 0
    v_dot2_f32_bf16 v122, v100, v20, 0
    v_dot2_f32_bf16 v123, v100, v100, 0
    v_dot2_f32_bf16 v120, v97, v20, v120
    v_dot2_f32_bf16 v121, v97, v97, v121
    v_dot2_f32_bf16 v122, v101, v20, v122
    v_dot2_f32_bf16 v123, v101, v101, v123
    v_dot2_f32_bf16 v120, v98, v20, v120
    v_dot2_f32_bf16 v121, v98, v98, v121
    s_add_u32 m0, s77, 40960
    s_add_u32 s74, s74, s90
    buffer_load_dwordx4 v2, s[12:15], s74 offen lds
    v_dot2_f32_bf16 v122, v102, v20, v122
    v_dot2_f32_bf16 v123, v102, v102, v123
    v_dot2_f32_bf16 v120, v99, v20, v120
    v_dot2_f32_bf16 v121, v99, v99, v121
    v_dot2_f32_bf16 v122, v103, v20, v122
    v_dot2_f32_bf16 v123, v103, v103, v123
    v_lshlrev_b32 v104, 16, v96
    v_and_b32 v105, 0xffff0000, v96
    v_lshlrev_b32 v106, 16, v97
    v_and_b32 v107, 0xffff0000, v97
    buffer_load_dwordx4 v3, s[12:15], s74 offen offset:1024 lds
    v_lshlrev_b32 v108, 16, v98
    v_and_b32 v109, 0xffff0000, v98
    v_lshlrev_b32 v110, 16, v99
    v_and_b32 v111, 0xffff0000, v99
    v_lshlrev_b32 v112, 16, v100
    v_and_b32 v113, 0xffff0000, v100
    v_lshlrev_b32 v114, 16, v101
    v_and_b32 v115, 0xffff0000, v101
    v_lshlrev_b32 v116, 16, v102
    v_and_b32 v117, 0xffff0000, v102
    s_add_u32 m0, s77, 49152
    s_add_u32 s74, s74, 1024
    buffer_load_dwordx4 v2, s[12:15], s74 offen lds
    v_lshlrev_b32 v118, 16, v103
    v_and_b32 v119, 0xffff0000, v103
    v_add_f32_dpp v120, v120, v120 row_shr:1 row_mask:0xf bank_mask:0xf bound_ctrl:1
    v_add_f32_dpp v121, v121, v121 row_shr:1 row_mask:0xf bank_mask:0xf bound_ctrl:1
    v_add_f32_dpp v122, v122, v122 row_shr:1 row_mask:0xf bank_mask:0xf bound_ctrl:1
    v_add_f32_dpp v123, v123, v123 row_shr:1 row_mask:0xf bank_mask:0xf bound_ctrl:1
    v_add_f32_dpp v120, v120, v120 row_shr:2 row_mask:0xf bank_mask:0xf bound_ctrl:1
    v_add_f32_dpp v121, v121, v121 row_shr:2 row_mask:0xf bank_mask:0xf bound_ctrl:1
    v_add_f32_dpp v122, v122, v122 row_shr:2 row_mask:0xf bank_mask:0xf bound_ctrl:1
    v_add_f32_dpp v123, v123, v123 row_shr:2 row_mask:0xf bank_mask:0xf bound_ctrl:1
    buffer_load_dwordx4 v3, s[12:15], s74 offen offset:1024 lds
    v_add_f32_dpp v120, v120, v120 row_shr:4 row_mask:0xf bank_mask:0xf bound_ctrl:1
    v_add_f32_dpp v121, v121, v121 row_shr:4 row_mask:0xf bank_mask:0xf bound_ctrl:1
    v_add_f32_dpp v122, v122, v122 row_shr:4 row_mask:0xf bank_mask:0xf bound_ctrl:1
    v_add_f32_dpp v123, v123, v123 row_shr:4 row_mask:0xf bank_mask:0xf bound_ctrl:1
    v_add_f32_dpp v120, v120, v120 row_shr:8 row_mask:0xf bank_mask:0xf bound_ctrl:1
    v_add_f32_dpp v121, v121, v121 row_shr:8 row_mask:0xf bank_mask:0xf bound_ctrl:1
    v_add_f32_dpp v122, v122, v122 row_shr:8 row_mask:0xf bank_mask:0xf bound_ctrl:1
    v_add_f32_dpp v123, v123, v123 row_shr:8 row_mask:0xf bank_mask:0xf bound_ctrl:1
    v_add_f32_dpp v120, v120, v120 row_bcast:15 row_mask:0xa bank_mask:0xf
    v_add_f32_dpp v121, v121, v121 row_bcast:15 row_mask:0xa bank_mask:0xf
    s_add_u32 m0, s77, 57344
    s_lshl_b32 s75, s76, 7
    s_add_u32 s75, s75, s73
    buffer_load_dwordx4 v4, s[8:11], s75 offen lds
    v_add_f32_dpp v122, v122, v122 row_bcast:15 row_mask:0xa bank_mask:0xf
    v_add_f32_dpp v123, v123, v123 row_bcast:15 row_mask:0xa bank_mask:0xf
    v_add_f32_dpp v120, v120, v120 row_bcast:31 row_mask:0xc bank_mask:0xf
    v_add_f32_dpp v121, v121, v121 row_bcast:31 row_mask:0xc bank_mask:0xf
    v_add_f32_dpp v122, v122, v122 row_bcast:31 row_mask:0xc bank_mask:0xf
    v_add_f32_dpp v123, v123, v123 row_bcast:31 row_mask:0xc bank_mask:0xf
    v_mov_b32 v124, 0x3727c5ac
    v_mul_f32 v120, 0xbb000000, v120
    v_mul_f32 v122, 0xbb000000, v122
    v_mul_f32 v121, 0x3b000000, v121
    buffer_load_dwordx4 v5, s[8:11], s75 offen offset:1024 lds
    v_mul_f32 v123, 0x3b000000, v123
    v_fma_f32 v121, -v120, v120, v121
    v_fma_f32 v123, -v122, v122, v123
    v_max_f32 v121, 0, v121
    v_max_f32 v123, 0, v123
    v_add_f32 v125, v121, v124
    v_add_f32 v126, v123, v124
    v_rsq_f32 v125, v125
    v_rsq_f32 v126, v126
    s_add_u32 m0, s77, 65536
    s_bfe_u32 s76, s71, 0x40008
    s_mul_i32 s74, s76, 196608
    s_add_u32 s74, s74, s72
    buffer_load_dwordx4 v2, s[12:15], s74 offen lds
    v_mul_f32 v121, v121, v125
    v_mul_f32 v123, v123, v126
    v_fma_f32 v121, v121, v125, v124
    v_fma_f32 v123, v123, v126, v124
    v_rsq_f32 v121, v121
    v_rsq_f32 v123, v123
    v_mul_f32 v121, v121, v125
    v_mul_f32 v123, v123, v126
    buffer_load_dwordx4 v3, s[12:15], s74 offen offset:1024 lds
    v_mul_f32 v120, v120, v121
    v_mul_f32 v122, v122, v123
    v_readlane_b32 s4, v120, 63
    v_readlane_b32 s5, v121, 63
    v_readlane_b32 s6, v122, 63
    v_readlane_b32 s7, v123, 63
    v_pk_fma_f32 v[104:105], v[104:105], s[4:5], s[4:5] op_sel:[0,1,0] op_sel_hi:[1,1,0]
    v_pk_fma_f32 v[106:107], v[106:107], s[4:5], s[4:5] op_sel:[0,1,0] op_sel_hi:[1,1,0]
    v_pk_fma_f32 v[108:109], v[108:109], s[4:5], s[4:5] op_sel:[0,1,0] op_sel_hi:[1,1,0]
    v_pk_fma_f32 v[110:111], v[110:111], s[4:5], s[4:5] op_sel:[0,1,0] op_sel_hi:[1,1,0]
    s_add_u32 m0, s77, 73728
    s_add_u32 s74, s74, s90
    buffer_load_dwordx4 v2, s[12:15], s74 offen lds
    v_pk_fma_f32 v[112:113], v[112:113], s[6:7], s[6:7] op_sel:[0,1,0] op_sel_hi:[1,1,0]
    v_pk_fma_f32 v[114:115], v[114:115], s[6:7], s[6:7] op_sel:[0,1,0] op_sel_hi:[1,1,0]
    v_pk_fma_f32 v[116:117], v[116:117], s[6:7], s[6:7] op_sel:[0,1,0] op_sel_hi:[1,1,0]
    v_pk_fma_f32 v[118:119], v[118:119], s[6:7], s[6:7] op_sel:[0,1,0] op_sel_hi:[1,1,0]
    v_cvt_pk_bf16_f32 v96, v104, v105
    v_cvt_pk_bf16_f32 v97, v106, v107
    v_cvt_pk_bf16_f32 v98, v108, v109
    v_cvt_pk_bf16_f32 v99, v110, v111
    v_cvt_pk_bf16_f32 v100, v112, v113
    v_cvt_pk_bf16_f32 v101, v114, v115
    buffer_load_dwordx4 v3, s[12:15], s74 offen offset:1024 lds
    v_cvt_pk_bf16_f32 v102, v116, v117
    v_cvt_pk_bf16_f32 v103, v118, v119
    s_add_u32 s4, s77, 131072
    v_add_u32 v16, s4, v1
    ds_write_b128 v16, v[96:99]
    ds_write_b128 v16, v[100:103] offset:1024
    s_lshl_b32 s4, s44, 3
    s_add_u32 s4, s4, s45
    s_lshl_b32 s4, s4, 9
    s_and_b32 s5, s45, 3
    s_lshl_b32 s5, s5, 8
    s_sub_u32 s4, s4, s5
    s_lshl_b32 s5, s3, 19
    s_add_u32 s4, s4, s5
    s_add_u32 s4, s4, 0
    s_add_u32 s5, s4, 262144
    s_waitcnt vmcnt(12) lgkmcnt(0)
    s_xor_b32 s91, s91, s64
    s_mul_i32 s91, s91, 0x2545f491
    s_add_u32 s64, s64, s91
    s_add_u32 s64, s64, 0x5bd3a6c7
    s_barrier
    v_mov_b32 v180, s64
    v_mov_b32 v181, s64
    v_mov_b32 v182, s64
    v_mov_b32 v183, s64
    ds_read_b64_tr_b16 v[160:161], v94 offset:0
    ds_read_b64_tr_b16 v[162:163], v94 offset:4096
    ds_read_b64_tr_b16 v[164:165], v94 offset:128
    ds_read_b64_tr_b16 v[166:167], v94 offset:4224
    ds_read_b64_tr_b16 v[116:117], v14 offset:0
    ds_read_b64_tr_b16 v[118:119], v14 offset:512
    ds_read_b64_tr_b16 v[120:121], v14 offset:8192
    ds_read_b64_tr_b16 v[122:123], v14 offset:8704
    ds_read_b64_tr_b16 v[124:125], v14 offset:16384
    ds_read_b64_tr_b16 v[126:127], v14 offset:16896
    ds_read_b128 v[96:99], v6 offset:0
    ds_read_b128 v[100:103], v6 offset:2048
    ds_read_b128 v[104:107], v6 offset:4096
    ds_read_b128 v[108:111], v6 offset:6144
    ds_read_b128 v[112:115], v10 offset:0
    s_waitcnt lgkmcnt(11)
    buffer_store_dwordx4 v[160:163], v95, s[28:31], s4 offen sc1
    buffer_store_dwordx4 v[164:167], v95, s[28:31], s5 offen sc1
    s_waitcnt lgkmcnt(0)
    v_mfma_f32_16x16x32_bf16 v[84:87], v[112:115], v[112:115], 0
    ds_read_b64_tr_b16 v[148:149], v14 offset:4096
    s_and_b32 s46, s3, 1
    v_smfmac_f32_16x16x64_bf16 v[88:91], v[80:83], v[112:119], v72
    ds_read_b64_tr_b16 v[150:151], v14 offset:4608
    s_lshr_b32 s47, s3, 1
    s_add_u32 m0, s77, 81920
    s_add_u32 s74, s74, 1024
    buffer_load_dwordx4 v2, s[12:15], s74 offen lds
    v_smfmac_f32_16x16x64_bf16 v[76:79], v[80:83], v[120:127], v72
    ds_read_b64_tr_b16 v[152:153], v14 offset:12288
    s_and_b32 s88, s65, 1
    v_mfma_f32_16x16x32_bf16 v[24:27], v[116:119], v[96:99], 0
    ds_read_b64_tr_b16 v[154:155], v14 offset:12800
    s_lshl_b32 s86, s88, 2
    v_mfma_f32_16x16x32_bf16 v[28:31], v[116:119], v[100:103], 0
    ds_read_b64_tr_b16 v[156:157], v14 offset:20480
    s_and_b32 s87, s66, 3
    buffer_load_dwordx4 v3, s[12:15], s74 offen offset:1024 lds
    v_mfma_f32_16x16x32_bf16 v[32:35], v[116:119], v[104:107], 0
    ds_read_b64_tr_b16 v[158:159], v14 offset:20992
    s_add_u32 s67, s86, s87
    v_mfma_f32_16x16x32_bf16 v[36:39], v[116:119], v[108:111], 0
    ds_read_b128 v[128:131], v7 offset:0
    s_mov_b32 s70, s67
    v_mfma_f32_16x16x32_bf16 v[40:43], v[96:99], v[120:123], 0
    ds_read_b128 v[132:135], v7 offset:2048
    s_lshr_b32 s82, s65, 1
    s_add_u32 m0, s77, 90112
    s_lshl_b32 s75, s76, 7
    s_add_u32 s75, s75, s73
    buffer_load_dwordx4 v4, s[8:11], s75 offen lds
    v_mfma_f32_16x16x32_bf16 v[56:59], v[96:99], v[124:127], 0
    ds_read_b128 v[136:139], v7 offset:4096
    s_mul_i32 s86, s82, 7
    v_mfma_f32_16x16x32_bf16 v[60:63], v[100:103], v[124:127], 0
    ds_read_b128 v[140:143], v7 offset:6144
    s_lshr_b32 s83, s66, 2
    v_mfma_f32_16x16x32_bf16 v[44:47], v[100:103], v[120:123], 0
    ds_read_b128 v[144:147], v11 offset:0
    s_add_u32 s68, s86, s83
    buffer_load_dwordx4 v5, s[8:11], s75 offen offset:1024 lds
    v_mfma_f32_16x16x32_bf16 v[48:51], v[104:107], v[120:123], 0
    s_lshl_b32 s86, s82, 2
    v_mfma_f32_16x16x32_bf16 v[64:67], v[104:107], v[124:127], 0
    s_sub_u32 s86, s66, s86
    v_mfma_f32_16x16x32_bf16 v[68:71], v[108:111], v[124:127], 0
    s_add_u32 s86, s86, 19
    s_add_u32 m0, s77, 98304
    s_bfe_u32 s76, s71, 0x4000c
    s_mul_i32 s74, s76, 196608
    s_add_u32 s74, s74, s72
    buffer_load_dwordx4 v2, s[12:15], s74 offen lds
    v_mfma_f32_16x16x32_bf16 v[52:55], v[108:111], v[120:123], 0
    s_sub_u32 s89, s86, 28
    s_waitcnt vmcnt(11)
    s_waitcnt lgkmcnt(0)
    s_barrier
    v_mfma_f32_16x16x32_bf16 v[84:87], v[144:147], v[144:147], v[84:87]
    ds_read_b64_tr_b16 v[116:117], v14 offset:32768
    s_cmp_ge_u32 s86, 28
    s_cselect_b32 s86, s89, s86
    v_smfmac_f32_16x16x64_bf16 v[88:91], v[80:83], v[144:151], v72
    ds_read_b64_tr_b16 v[118:119], v14 offset:33280
    s_mul_i32 s89, s86, 37
    buffer_load_dwordx4 v3, s[12:15], s74 offen offset:1024 lds
    v_smfmac_f32_16x16x64_bf16 v[76:79], v[80:83], v[152:159], v72
    ds_read_b64_tr_b16 v[120:121], v14 offset:40960
    s_lshr_b32 s89, s89, 8
    v_mfma_f32_16x16x32_bf16 v[24:27], v[148:151], v[128:131], v[24:27]
    ds_read_b64_tr_b16 v[122:123], v14 offset:41472
    s_mul_i32 s51, s89, 7
    v_mfma_f32_16x16x32_bf16 v[28:31], v[148:151], v[132:135], v[28:31]
    ds_read_b64_tr_b16 v[124:125], v14 offset:49152
    s_sub_u32 s86, s86, s51
    s_add_u32 m0, s77, 106496
    s_add_u32 s74, s74, s90
    buffer_load_dwordx4 v2, s[12:15], s74 offen lds
    v_mfma_f32_16x16x32_bf16 v[32:35], v[148:151], v[136:139], v[32:35]
    ds_read_b64_tr_b16 v[126:127], v14 offset:49664
    s_cmp_eq_u32 s83, 7
    s_cselect_b32 s51, 7, s86
    s_cselect_b32 s55, s87, s89
    v_mfma_f32_16x16x32_bf16 v[36:39], v[148:151], v[140:143], v[36:39]
    ds_read_b128 v[96:99], v6 offset:32768
    s_lshl_b32 s86, s88, 2
    v_mfma_f32_16x16x32_bf16 v[40:43], v[128:131], v[152:155], v[40:43]
    ds_read_b128 v[100:103], v6 offset:34816
    s_add_u32 s70, s86, s55
    buffer_load_dwordx4 v3, s[12:15], s74 offen offset:1024 lds
    v_mfma_f32_16x16x32_bf16 v[56:59], v[128:131], v[156:159], v[56:59]
    ds_read_b128 v[104:107], v6 offset:36864
    s_lshl_b32 s86, s51, 2
    v_mfma_f32_16x16x32_bf16 v[60:63], v[132:135], v[156:159], v[60:63]
    ds_read_b128 v[108:111], v6 offset:38912
    s_lshr_b32 s86, 0x37654210, s86
    v_mfma_f32_16x16x32_bf16 v[44:47], v[132:135], v[152:155], v[44:47]
    ds_read_b128 v[112:115], v10 offset:32768
    s_and_b32 s86, s86, 7
    s_add_u32 m0, s77, 114688
    s_add_u32 s74, s74, 1024
    buffer_load_dwordx4 v2, s[12:15], s74 offen lds
    v_mfma_f32_16x16x32_bf16 v[48:51], v[136:139], v[152:155], v[48:51]
    s_lshl_b32 s82, s82, 3
    v_mfma_f32_16x16x32_bf16 v[64:67], v[136:139], v[156:159], v[64:67]
    s_add_u32 s69, s86, s82
    v_mfma_f32_16x16x32_bf16 v[68:71], v[140:143], v[156:159], v[68:71]
    s_sub_u32 s89, s87, s83
    buffer_load_dwordx4 v3, s[12:15], s74 offen offset:1024 lds
    v_mfma_f32_16x16x32_bf16 v[52:55], v[140:143], v[152:155], v[52:55]
    s_and_b32 s89, s89, 3
    s_waitcnt lgkmcnt(0)
    v_mfma_f32_16x16x32_bf16 v[84:87], v[112:115], v[112:115], v[84:87]
    ds_read_b64_tr_b16 v[148:149], v14 offset:36864
    s_mov_b32 s52, 0x68532410
    v_smfmac_f32_16x16x64_bf16 v[88:91], v[80:83], v[112:119], v72
    ds_read_b64_tr_b16 v[150:151], v14 offset:37376
    s_mov_b32 s53, 0xfedbac97
    s_add_u32 m0, s77, 122880
    s_lshl_b32 s75, s76, 7
    s_add_u32 s75, s75, s73
    buffer_load_dwordx4 v4, s[8:11], s75 offen lds
    v_smfmac_f32_16x16x64_bf16 v[76:79], v[80:83], v[120:127], v72
    ds_read_b64_tr_b16 v[152:153], v14 offset:45056
    s_cmp_eq_u32 s89, 1
    s_cselect_b32 s52, 0x96435201, s52
    s_cselect_b32 s53, 0xfecbda87, s53
    v_mfma_f32_16x16x32_bf16 v[24:27], v[116:119], v[96:99], v[24:27]
    ds_read_b64_tr_b16 v[154:155], v14 offset:45568
    s_cmp_eq_u32 s89, 2
    s_cselect_b32 s52, 0x75463102, s52
    s_cselect_b32 s53, 0xfdceb98a, s53
    v_mfma_f32_16x16x32_bf16 v[28:31], v[116:119], v[100:103], v[28:31]
    ds_read_b64_tr_b16 v[156:157], v14 offset:53248
    s_cmp_eq_u32 s89, 3
    s_cselect_b32 s52, 0x65742130, s52
    s_cselect_b32 s53, 0xedfca9b8, s53
    buffer_load_dwordx4 v5, s[8:11], s75 offen offset:1024 lds
    v_mfma_f32_16x16x32_bf16 v[32:35], v[116:119], v[104:107], v[32:35]
    ds_read_b64_tr_b16 v[158:159], v14 offset:53760
    s_sub_u32 s89, s70, s51
    v_mfma_f32_16x16x32_bf16 v[36:39], v[116:119], v[108:111], v[36:39]
    ds_read_b128 v[128:131], v7 offset:32768
    s_and_b32 s89, s89, 3
    v_mfma_f32_16x16x32_bf16 v[40:43], v[96:99], v[120:123], v[40:43]
    ds_read_b128 v[132:135], v7 offset:34816
    s_mov_b32 s54, 0x3210
    s_add_u32 m0, s77, 0
    s_bfe_u32 s76, s71, 0x40010
    s_mul_i32 s74, s76, 196608
    s_add_u32 s74, s74, s72
    buffer_load_dwordx4 v2, s[12:15], s74 offen lds
    v_mfma_f32_16x16x32_bf16 v[56:59], v[96:99], v[124:127], v[56:59]
    ds_read_b128 v[136:139], v7 offset:36864
    s_cmp_eq_u32 s89, 1
    s_cselect_b32 s54, 0x3201, s54
    v_mfma_f32_16x16x32_bf16 v[60:63], v[100:103], v[124:127], v[60:63]
    ds_read_b128 v[140:143], v7 offset:38912
    s_cmp_eq_u32 s89, 2
    s_cselect_b32 s54, 0x3102, s54
    v_mfma_f32_16x16x32_bf16 v[44:47], v[100:103], v[120:123], v[44:47]
    ds_read_b128 v[144:147], v11 offset:32768
L_w1:
    s_cbranch_execz L_w5
    s_cmp_eq_u32 s89, 3
    s_cselect_b32 s54, 0x2130, s54
    buffer_load_dwordx4 v3, s[12:15], s74 offen offset:1024 lds
    v_mfma_f32_16x16x32_bf16 v[48:51], v[104:107], v[120:123], v[48:51]
    s_lshl_b32 s86, s88, 2
    v_mfma_f32_16x16x32_bf16 v[64:67], v[104:107], v[124:127], v[64:67]
    s_add_u32 s89, s89, s86
    v_mfma_f32_16x16x32_bf16 v[68:71], v[108:111], v[124:127], v[68:71]
    s_mov_b32 s56, 0x98543210
    s_add_u32 m0, s77, 8192
    s_add_u32 s74, s74, s90
    buffer_load_dwordx4 v2, s[12:15], s74 offen lds
    v_mfma_f32_16x16x32_bf16 v[52:55], v[108:111], v[120:123], v[52:55]
    s_mov_b32 s57, 0xdcba76
    s_waitcnt vmcnt(11)
    s_waitcnt lgkmcnt(0)
    s_barrier
    s_cmp_lg_u32 s3, 0
    s_cbranch_scc1 L_sigc1
    s_lshr_b32 s4, s2, 3
    s_lshl_b32 s4, s4, 7
    s_and_b32 s5, s2, 7
    s_lshl_b32 s5, s5, 2
    s_add_u32 s4, s4, s5
    s_add_u32 s4, s4, 10223616
    s_mov_b64 exec, 1
    buffer_store_dword v180, off, s[28:31], s4 sc1
    s_mov_b64 exec, -1
L_sigc1:
    v_mfma_f32_16x16x32_bf16 v[84:87], v[144:147], v[144:147], v[84:87]
    ds_read_b64_tr_b16 v[116:117], v15 offset:0
    s_cmp_eq_u32 s89, 1
    s_cselect_b32 s56, 0x76541032, s56
    s_cselect_b32 s57, 0xdc98ba, s57
    v_smfmac_f32_16x16x64_bf16 v[88:91], v[80:83], v[144:151], v72
    ds_read_b64_tr_b16 v[118:119], v15 offset:512
    s_cmp_eq_u32 s89, 2
    s_cselect_b32 s56, 0x76325410, s56
    s_cselect_b32 s57, 0xbadc98, s57
    buffer_load_dwordx4 v3, s[12:15], s74 offen offset:1024 lds
    v_smfmac_f32_16x16x64_bf16 v[76:79], v[80:83], v[152:159], v72
    ds_read_b64_tr_b16 v[120:121], v15 offset:8192
    s_cmp_eq_u32 s89, 3
    s_cselect_b32 s56, 0x54763210, s56
    s_cselect_b32 s57, 0xdcba98, s57
    v_mfma_f32_16x16x32_bf16 v[24:27], v[148:151], v[128:131], v[24:27]
    ds_read_b64_tr_b16 v[122:123], v15 offset:8704
    s_cmp_eq_u32 s89, 4
    s_cselect_b32 s56, 0x32dcba98, s56
    s_cselect_b32 s57, 0x765410, s57
    v_mfma_f32_16x16x32_bf16 v[28:31], v[148:151], v[132:135], v[28:31]
    ds_read_b64_tr_b16 v[124:125], v15 offset:16384
    s_cmp_eq_u32 s89, 5
    s_cselect_b32 s56, 0x10dc98ba, s56
    s_cselect_b32 s57, 0x763254, s57
    s_add_u32 m0, s77, 16384
    s_add_u32 s74, s74, 1024
    buffer_load_dwordx4 v2, s[12:15], s74 offen lds
    v_mfma_f32_16x16x32_bf16 v[32:35], v[148:151], v[136:139], v[32:35]
    ds_read_b64_tr_b16 v[126:127], v15 offset:16896
    s_cmp_eq_u32 s89, 6
    s_cselect_b32 s56, 0x10badc98, s56
    s_cselect_b32 s57, 0x547632, s57
    v_mfma_f32_16x16x32_bf16 v[36:39], v[148:151], v[140:143], v[36:39]
    ds_read_b128 v[96:99], v8 offset:0
    s_cmp_eq_u32 s89, 7
    s_cselect_b32 s56, 0xdc10ba98, s56
    s_cselect_b32 s57, 0x765432, s57
    v_mfma_f32_16x16x32_bf16 v[40:43], v[128:131], v[152:155], v[40:43]
    ds_read_b128 v[100:103], v8 offset:2048
    s_mul_i32 s88, s88, 0x88888888
    buffer_load_dwordx4 v3, s[12:15], s74 offen offset:1024 lds
    v_mfma_f32_16x16x32_bf16 v[56:59], v[128:131], v[156:159], v[56:59]
    ds_read_b128 v[104:107], v8 offset:4096
    s_xor_b32 s52, s52, s88
    v_mfma_f32_16x16x32_bf16 v[60:63], v[132:135], v[156:159], v[60:63]
    ds_read_b128 v[108:111], v8 offset:6144
    s_xor_b32 s53, s53, s88
    v_mfma_f32_16x16x32_bf16 v[44:47], v[132:135], v[152:155], v[44:47]
    ds_read_b128 v[112:115], v12 offset:0
    s_lshl_b32 s58, s68, 7
    s_add_u32 m0, s77, 24576
    s_lshl_b32 s75, s76, 7
    s_add_u32 s75, s75, s73
    buffer_load_dwordx4 v4, s[8:11], s75 offen lds
    v_mfma_f32_16x16x32_bf16 v[48:51], v[136:139], v[152:155], v[48:51]
    s_lshl_b32 s59, s70, 7
    v_mfma_f32_16x16x32_bf16 v[64:67], v[136:139], v[156:159], v[64:67]
    s_lshl_b32 s60, s69, 7
    v_mfma_f32_16x16x32_bf16 v[68:71], v[140:143], v[156:159], v[68:71]
    s_lshl_b32 s86, s67, 1
    buffer_load_dwordx4 v5, s[8:11], s75 offen offset:1024 lds
    v_mfma_f32_16x16x32_bf16 v[52:55], v[140:143], v[152:155], v[52:55]
    s_add_u32 s80, s86, s47
    s_waitcnt lgkmcnt(0)
    v_mfma_f32_16x16x32_bf16 v[84:87], v[112:115], v[112:115], v[84:87]
    ds_read_b64_tr_b16 v[148:149], v15 offset:4096
    s_lshl_b32 s86, s69, 1
    v_smfmac_f32_16x16x64_bf16 v[88:91], v[80:83], v[112:119], v72
    ds_read_b64_tr_b16 v[150:151], v15 offset:4608
    s_add_u32 s48, s86, s46
    s_add_u32 m0, s77, 32768
    s_bfe_u32 s76, s71, 0x40014
    s_mul_i32 s74, s76, 196608
    s_add_u32 s74, s74, s72
    buffer_load_dwordx4 v2, s[12:15], s74 offen lds
    v_smfmac_f32_16x16x64_bf16 v[76:79], v[80:83], v[120:127], v72
    ds_read_b64_tr_b16 v[152:153], v15 offset:12288
    s_lshl_b32 s86, s70, 1
    v_mfma_f32_16x16x32_bf16 v[24:27], v[116:119], v[96:99], v[24:27]
    ds_read_b64_tr_b16 v[154:155], v15 offset:12800
    s_add_u32 s49, s86, s47
    v_mfma_f32_16x16x32_bf16 v[28:31], v[116:119], v[100:103], v[28:31]
    ds_read_b64_tr_b16 v[156:157], v15 offset:20480
    s_lshl_b32 s87, s46, 12
    buffer_load_dwordx4 v3, s[12:15], s74 offen offset:1024 lds
    v_mfma_f32_16x16x32_bf16 v[32:35], v[116:119], v[104:107], v[32:35]
    ds_read_b64_tr_b16 v[158:159], v15 offset:20992
    s_lshl_b32 s88, s47, 12
    v_mfma_f32_16x16x32_bf16 v[36:39], v[116:119], v[108:111], v[36:39]
    ds_read_b128 v[128:131], v9 offset:0
    s_lshl_b32 s86, s80, 17
    v_mfma_f32_16x16x32_bf16 v[40:43], v[96:99], v[120:123], v[40:43]
    ds_read_b128 v[132:135], v9 offset:2048
    s_add_u32 s86, s86, s87
    s_add_u32 m0, s77, 40960
    s_add_u32 s74, s74, s90
    buffer_load_dwordx4 v2, s[12:15], s74 offen lds
    v_mfma_f32_16x16x32_bf16 v[56:59], v[96:99], v[124:127], v[56:59]
    ds_read_b128 v[136:139], v9 offset:4096
    s_add_u32 s61, s86, 0
    v_mfma_f32_16x16x32_bf16 v[60:63], v[100:103], v[124:127], v[60:63]
    ds_read_b128 v[140:143], v9 offset:6144
    s_lshl_b32 s86, s69, 16
    v_mfma_f32_16x16x32_bf16 v[44:47], v[100:103], v[120:123], v[44:47]
    ds_read_b128 v[144:147], v13 offset:0
    s_add_u32 s50, s86, s59
    buffer_load_dwordx4 v3, s[12:15], s74 offen offset:1024 lds
    v_mfma_f32_16x16x32_bf16 v[48:51], v[104:107], v[120:123], v[48:51]
    s_lshl_b32 s86, s48, 15
    v_mfma_f32_16x16x32_bf16 v[64:67], v[104:107], v[124:127], v[64:67]
    s_add_u32 s86, s86, s88
    v_mfma_f32_16x16x32_bf16 v[68:71], v[108:111], v[124:127], v[68:71]
    s_add_u32 s62, s86, 6291456
    s_add_u32 m0, s77, 49152
    s_add_u32 s74, s74, 1024
    buffer_load_dwordx4 v2, s[12:15], s74 offen lds
    v_mfma_f32_16x16x32_bf16 v[52:55], v[108:111], v[120:123], v[52:55]
    s_mul_i32 s86, s49, 114688
    s_waitcnt vmcnt(13)
    s_waitcnt lgkmcnt(0)
    s_barrier
    v_mfma_f32_16x16x32_bf16 v[84:87], v[144:147], v[144:147], v[84:87]
    ds_read_b64_tr_b16 v[116:117], v15 offset:32768
    s_add_u32 s86, s86, s87
    v_smfmac_f32_16x16x64_bf16 v[88:91], v[80:83], v[144:151], v72
    ds_read_b64_tr_b16 v[118:119], v15 offset:33280
    s_add_u32 s63, s86, 2097152
    buffer_load_dwordx4 v3, s[12:15], s74 offen offset:1024 lds
    v_smfmac_f32_16x16x64_bf16 v[76:79], v[80:83], v[152:159], v72
    ds_read_b64_tr_b16 v[120:121], v15 offset:40960
    v_lshrrev_b32 v16, 3, v0
    v_mfma_f32_16x16x32_bf16 v[24:27], v[148:151], v[128:131], v[24:27]
    ds_read_b64_tr_b16 v[122:123], v15 offset:41472
    v_and_b32 v17, 7, v0
    v_mfma_f32_16x16x32_bf16 v[28:31], v[148:151], v[132:135], v[28:31]
    ds_read_b64_tr_b16 v[124:125], v15 offset:49152
    v_lshlrev_b32 v18, 7, v16
    s_add_u32 m0, s77, 57344
    s_lshl_b32 s75, s76, 7
    s_add_u32 s75, s75, s73
    buffer_load_dwordx4 v4, s[8:11], s75 offen lds
    v_mfma_f32_16x16x32_bf16 v[32:35], v[148:151], v[136:139], v[32:35]
    ds_read_b64_tr_b16 v[126:127], v15 offset:49664
    v_lshl_add_u32 v219, v17, 2, v18
    v_mfma_f32_16x16x32_bf16 v[36:39], v[148:151], v[140:143], v[36:39]
    ds_read_b128 v[96:99], v8 offset:32768
    v_lshlrev_b32 v18, 15, v16
    v_mfma_f32_16x16x32_bf16 v[40:43], v[128:131], v[152:155], v[40:43]
    ds_read_b128 v[100:103], v8 offset:34816
    v_lshl_add_u32 v253, v17, 4, v18
    buffer_load_dwordx4 v5, s[8:11], s75 offen offset:1024 lds
    v_mfma_f32_16x16x32_bf16 v[56:59], v[128:131], v[156:159], v[56:59]
    ds_read_b128 v[104:107], v8 offset:36864
    v_and_b32 v18, 2, v16
    v_mfma_f32_16x16x32_bf16 v[60:63], v[132:135], v[156:159], v[60:63]
    ds_read_b128 v[108:111], v8 offset:38912
    v_xor_b32 v19, v17, v18
    v_mfma_f32_16x16x32_bf16 v[44:47], v[132:135], v[152:155], v[44:47]
    ds_read_b128 v[112:115], v12 offset:32768
    v_lshlrev_b32 v18, 1, v18
    s_add_u32 m0, s77, 65536
    s_bfe_u32 s76, s71, 0x40018
    s_mul_i32 s74, s76, 196608
    s_add_u32 s74, s74, s72
    buffer_load_dwordx4 v2, s[12:15], s74 offen lds
    v_mfma_f32_16x16x32_bf16 v[48:51], v[136:139], v[152:155], v[48:51]
    v_xor_b32 v17, v17, v18
    v_mfma_f32_16x16x32_bf16 v[64:67], v[136:139], v[156:159], v[64:67]
    v_lshlrev_b32 v17, 4, v17
    v_mfma_f32_16x16x32_bf16 v[68:71], v[140:143], v[156:159], v[68:71]
    v_lshl_add_u32 v16, s3, 5, v16
    buffer_load_dwordx4 v3, s[12:15], s74 offen offset:1024 lds
    v_mfma_f32_16x16x32_bf16 v[52:55], v[140:143], v[152:155], v[52:55]
    v_mul_u32_u24 v18, 3584, v16
    s_waitcnt lgkmcnt(0)
    v_mfma_f32_16x16x32_bf16 v[84:87], v[112:115], v[112:115], v[84:87]
    ds_read_b64_tr_b16 v[148:149], v15 offset:36864
    v_lshl_add_u32 v192, v19, 4, v18
    v_smfmac_f32_16x16x64_bf16 v[88:91], v[80:83], v[112:119], v72
    ds_read_b64_tr_b16 v[150:151], v15 offset:37376
    v_xor_b32 v19, 64, v192
    s_add_u32 m0, s77, 73728
    s_add_u32 s74, s74, s90
    buffer_load_dwordx4 v2, s[12:15], s74 offen lds
    v_smfmac_f32_16x16x64_bf16 v[76:79], v[80:83], v[120:127], v72
    ds_read_b64_tr_b16 v[152:153], v15 offset:45056
    v_add_u32 v193, 27648, v19
    v_mfma_f32_16x16x32_bf16 v[24:27], v[116:119], v[96:99], v[24:27]
    ds_read_b64_tr_b16 v[154:155], v15 offset:45568
    v_add_u32 v194, 55296, v192
    v_mfma_f32_16x16x32_bf16 v[28:31], v[116:119], v[100:103], v[28:31]
    ds_read_b64_tr_b16 v[156:157], v15 offset:53248
    v_add_u32 v195, 82944, v19
    buffer_load_dwordx4 v3, s[12:15], s74 offen offset:1024 lds
    v_mfma_f32_16x16x32_bf16 v[32:35], v[116:119], v[104:107], v[32:35]
    ds_read_b64_tr_b16 v[158:159], v15 offset:53760
    v_mul_u32_u24 v18, 1024, v16
    v_mfma_f32_16x16x32_bf16 v[36:39], v[116:119], v[108:111], v[36:39]
    ds_read_b128 v[128:131], v9 offset:32768
    v_add_u32 v196, v18, v17
    v_mfma_f32_16x16x32_bf16 v[40:43], v[96:99], v[120:123], v[40:43]
    ds_read_b128 v[132:135], v9 offset:34816
    v_add_u32 v197, 7168, v196
    s_add_u32 m0, s77, 81920
    s_add_u32 s74, s74, 1024
    buffer_load_dwordx4 v2, s[12:15], s74 offen lds
    v_mfma_f32_16x16x32_bf16 v[56:59], v[96:99], v[124:127], v[56:59]
    ds_read_b128 v[136:139], v9 offset:36864
    v_add_u32 v198, 14336, v196
    v_mfma_f32_16x16x32_bf16 v[60:63], v[100:103], v[124:127], v[60:63]
    ds_read_b128 v[140:143], v9 offset:38912
    v_add_u32 v199, 21504, v196
    v_mfma_f32_16x16x32_bf16 v[44:47], v[100:103], v[120:123], v[44:47]
    ds_read_b128 v[144:147], v13 offset:32768
    v_mul_u32_u24 v18, 4096, v16
    buffer_load_dwordx4 v3, s[12:15], s74 offen offset:1024 lds
    v_mfma_f32_16x16x32_bf16 v[48:51], v[104:107], v[120:123], v[48:51]
    v_and_b32 v17, 6, v16
    v_mfma_f32_16x16x32_bf16 v[64:67], v[104:107], v[124:127], v[64:67]
    v_xor_b32 v17, v17, v0
    v_mfma_f32_16x16x32_bf16 v[68:71], v[108:111], v[124:127], v[68:71]
    v_and_b32 v17, 7, v17
    s_add_u32 m0, s77, 90112
    s_lshl_b32 s75, s76, 7
    s_add_u32 s75, s75, s73
    buffer_load_dwordx4 v4, s[8:11], s75 offen lds
    v_mfma_f32_16x16x32_bf16 v[52:55], v[108:111], v[120:123], v[52:55]
    v_lshlrev_b32 v17, 4, v17
    s_waitcnt vmcnt(15)
    s_waitcnt lgkmcnt(0)
    s_barrier
    v_mfma_f32_16x16x32_bf16 v[84:87], v[144:147], v[144:147], v[84:87]
    ds_read_b64_tr_b16 v[116:117], v14 offset:0
    v_add_u32 v200, v18, v17
    v_smfmac_f32_16x16x64_bf16 v[88:91], v[80:83], v[144:151], v72
    ds_read_b64_tr_b16 v[118:119], v14 offset:512
    v_add_u32 v201, 31744, v200
    buffer_load_dwordx4 v5, s[8:11], s75 offen offset:1024 lds
    v_smfmac_f32_16x16x64_bf16 v[76:79], v[80:83], v[152:159], v72
    ds_read_b64_tr_b16 v[120:121], v14 offset:8192
    v_add_u32 v202, 63488, v200
    v_mfma_f32_16x16x32_bf16 v[24:27], v[148:151], v[128:131], v[24:27]
    ds_read_b64_tr_b16 v[122:123], v14 offset:8704
    v_add_u32 v203, 95232, v200
    v_mfma_f32_16x16x32_bf16 v[28:31], v[148:151], v[132:135], v[28:31]
    ds_read_b64_tr_b16 v[124:125], v14 offset:16384
    v_bfe_u32 v16, v0, 2, 2
    s_add_u32 m0, s77, 98304
    s_bfe_u32 s76, s71, 0x4001c
    s_mul_i32 s74, s76, 196608
    s_add_u32 s74, s74, s72
    buffer_load_dwordx4 v2, s[12:15], s74 offen lds
    v_mfma_f32_16x16x32_bf16 v[32:35], v[148:151], v[136:139], v[32:35]
    ds_read_b64_tr_b16 v[126:127], v14 offset:16896
    v_bfrev_b32 v17, v0
    v_mfma_f32_16x16x32_bf16 v[36:39], v[148:151], v[140:143], v[36:39]
    ds_read_b128 v[96:99], v6 offset:0
    v_lshrrev_b32 v17, 30, v17
    v_mfma_f32_16x16x32_bf16 v[40:43], v[128:131], v[152:155], v[40:43]
    ds_read_b128 v[100:103], v6 offset:2048
    v_lshlrev_b32 v17, 3, v17
    buffer_load_dwordx4 v3, s[12:15], s74 offen offset:1024 lds
    v_mfma_f32_16x16x32_bf16 v[56:59], v[128:131], v[156:159], v[56:59]
    ds_read_b128 v[104:107], v6 offset:4096
    v_lshl_add_u32 v17, v16, 7, v17
    v_mfma_f32_16x16x32_bf16 v[60:63], v[132:135], v[156:159], v[60:63]
    ds_read_b128 v[108:111], v6 offset:6144
    v_and_b32 v18, 16, v0
    v_mfma_f32_16x16x32_bf16 v[44:47], v[132:135], v[152:155], v[44:47]
    ds_read_b128 v[112:115], v10 offset:0
    v_lshl_add_u32 v17, v18, 1, v17
    s_add_u32 m0, s77, 106496
    s_add_u32 s74, s74, s90
    buffer_load_dwordx4 v2, s[12:15], s74 offen lds
    v_mfma_f32_16x16x32_bf16 v[48:51], v[136:139], v[152:155], v[48:51]
    v_and_b32 v16, 2, v16
    v_mfma_f32_16x16x32_bf16 v[64:67], v[136:139], v[156:159], v[64:67]
    v_lshl_add_u32 v17, v16, 5, v17
    v_mfma_f32_16x16x32_bf16 v[68:71], v[140:143], v[156:159], v[68:71]
    v_lshrrev_b32 v18, 5, v0
    buffer_load_dwordx4 v3, s[12:15], s74 offen offset:1024 lds
    v_mfma_f32_16x16x32_bf16 v[52:55], v[140:143], v[152:155], v[52:55]
    s_mul_i32 s87, s46, 8256
    s_waitcnt lgkmcnt(0)
    v_mfma_f32_16x16x32_bf16 v[84:87], v[112:115], v[112:115], v[84:87]
    ds_read_b64_tr_b16 v[148:149], v14 offset:4096
    s_mul_i32 s88, s47, 8256
    v_smfmac_f32_16x16x64_bf16 v[88:91], v[80:83], v[112:119], v72
    ds_read_b64_tr_b16 v[150:151], v14 offset:4608
    s_lshl_b32 s86, s3, 5
    s_add_u32 m0, s77, 114688
    s_add_u32 s74, s74, 1024
    buffer_load_dwordx4 v2, s[12:15], s74 offen lds
    v_smfmac_f32_16x16x64_bf16 v[76:79], v[80:83], v[120:127], v72
    ds_read_b64_tr_b16 v[152:153], v14 offset:12288
    s_xor_b32 s86, s86, s87
    v_mfma_f32_16x16x32_bf16 v[24:27], v[116:119], v[96:99], v[24:27]
    ds_read_b64_tr_b16 v[154:155], v14 offset:12800
    v_xor_b32 v204, s86, v14
    v_mfma_f32_16x16x32_bf16 v[28:31], v[116:119], v[100:103], v[28:31]
    ds_read_b64_tr_b16 v[156:157], v14 offset:20480
    v_xor_b32 v205, 32, v204
    buffer_load_dwordx4 v3, s[12:15], s74 offen offset:1024 lds
    v_mfma_f32_16x16x32_bf16 v[32:35], v[116:119], v[104:107], v[32:35]
    ds_read_b64_tr_b16 v[158:159], v14 offset:20992
    v_xor_b32 v206, 64, v204
    v_mfma_f32_16x16x32_bf16 v[36:39], v[116:119], v[108:111], v[36:39]
    ds_read_b128 v[128:131], v7 offset:0
    v_xor_b32 v207, 96, v204
    v_mfma_f32_16x16x32_bf16 v[40:43], v[96:99], v[120:123], v[40:43]
    ds_read_b128 v[132:135], v7 offset:2048
    v_lshl_add_u32 v19, v18, 9, v17
    s_add_u32 m0, s77, 122880
    s_lshl_b32 s75, s76, 7
    s_add_u32 s75, s75, s73
    buffer_load_dwordx4 v4, s[8:11], s75 offen lds
    v_mfma_f32_16x16x32_bf16 v[56:59], v[96:99], v[124:127], v[56:59]
    ds_read_b128 v[136:139], v7 offset:4096
    v_xor_b32 v208, s88, v19
    v_mfma_f32_16x16x32_bf16 v[60:63], v[100:103], v[124:127], v[60:63]
    ds_read_b128 v[140:143], v7 offset:6144
    v_xor_b32 v209, 64, v208
    v_mfma_f32_16x16x32_bf16 v[44:47], v[100:103], v[120:123], v[44:47]
    ds_read_b128 v[144:147], v11 offset:0
    v_add_u32 v210, 0x10000, v208
    buffer_load_dwordx4 v5, s[8:11], s75 offen offset:1024 lds
    v_mfma_f32_16x16x32_bf16 v[48:51], v[104:107], v[120:123], v[48:51]
    v_add_u32 v211, 0x10000, v209
    v_mfma_f32_16x16x32_bf16 v[64:67], v[104:107], v[124:127], v[64:67]
    v_and_b32 v19, 48, v0
    v_mfma_f32_16x16x32_bf16 v[68:71], v[108:111], v[124:127], v[68:71]
    v_lshlrev_b32 v19, 5, v19
    v_mfma_f32_16x16x32_bf16 v[52:55], v[108:111], v[120:123], v[52:55]
    v_sub_u32 v212, v204, v19
    v_sub_u32 v213, v205, v19
    v_sub_u32 v214, v206, v19
    v_sub_u32 v215, v207, v19
    s_add_u32 s86, s78, 147456
    v_add_u32 v216, s86, v1
    s_cmp_ge_u32 s66, 28
    s_cbranch_scc1 L_helper
    s_waitcnt vmcnt(16)
    s_waitcnt lgkmcnt(0)
    s_barrier
    v_and_b32 v16, 31, v0
    v_lshlrev_b32 v16, 1, v16
    s_lshl_b32 s4, s48, 6
    buffer_load_ushort v254, v16, s[40:43], s4 offen
    s_lshl_b32 s4, s68, 7
    s_lshl_b32 s5, s46, 6
    s_add_u32 s4, s4, s5
    v_lshrrev_b32 v16, 4, v0
    v_lshlrev_b32 v16, 3, v16
    buffer_load_dwordx2 v[236:237], v16, s[36:39], s4 offen offset:0
    buffer_load_dwordx2 v[238:239], v16, s[36:39], s4 offen offset:32
    v_mfma_f32_16x16x32_bf16 v[84:87], v[144:147], v[144:147], v[84:87]
    ds_read_b64_tr_b16 v[116:117], v14 offset:32768
    v_smfmac_f32_16x16x64_bf16 v[88:91], v[80:83], v[144:151], v72
    ds_read_b64_tr_b16 v[118:119], v14 offset:33280
    s_bfe_u32 s76, s52, 0x40000
    s_mul_i32 s74, s76, 458752
    s_add_u32 m0, s78, 0
    s_add_u32 s74, s74, s58
    buffer_load_dwordx4 v192, s[20:23], s74 offen lds
    v_smfmac_f32_16x16x64_bf16 v[76:79], v[80:83], v[152:159], v72
    ds_read_b64_tr_b16 v[120:121], v14 offset:40960
    v_mfma_f32_16x16x32_bf16 v[24:27], v[148:151], v[128:131], v[24:27]
    ds_read_b64_tr_b16 v[122:123], v14 offset:41472
    v_mfma_f32_16x16x32_bf16 v[28:31], v[148:151], v[132:135], v[28:31]
    ds_read_b64_tr_b16 v[124:125], v14 offset:49152
    buffer_load_dwordx4 v193, s[20:23], s74 offen offset:1024 lds
    v_mfma_f32_16x16x32_bf16 v[32:35], v[148:151], v[136:139], v[32:35]
    ds_read_b64_tr_b16 v[126:127], v14 offset:49664
    v_mfma_f32_16x16x32_bf16 v[36:39], v[148:151], v[140:143], v[36:39]
    ds_read_b128 v[96:99], v6 offset:32768
    v_mfma_f32_16x16x32_bf16 v[40:43], v[128:131], v[152:155], v[40:43]
    ds_read_b128 v[100:103], v6 offset:34816
    buffer_load_dwordx4 v194, s[20:23], s74 offen offset:2048 lds
    v_mfma_f32_16x16x32_bf16 v[56:59], v[128:131], v[156:159], v[56:59]
    ds_read_b128 v[104:107], v6 offset:36864
    v_mfma_f32_16x16x32_bf16 v[60:63], v[132:135], v[156:159], v[60:63]
    ds_read_b128 v[108:111], v6 offset:38912
    v_mfma_f32_16x16x32_bf16 v[44:47], v[132:135], v[152:155], v[44:47]
    ds_read_b128 v[112:115], v10 offset:32768
    buffer_load_dwordx4 v195, s[20:23], s74 offen offset:3072 lds
    v_mfma_f32_16x16x32_bf16 v[48:51], v[136:139], v[152:155], v[48:51]
    v_mfma_f32_16x16x32_bf16 v[64:67], v[136:139], v[156:159], v[64:67]
    v_mfma_f32_16x16x32_bf16 v[68:71], v[140:143], v[156:159], v[68:71]
    s_bfe_u32 s76, s52, 0x40004
    s_mul_i32 s74, s76, 458752
    s_add_u32 m0, s78, 16384
    s_add_u32 s74, s74, s58
    buffer_load_dwordx4 v192, s[20:23], s74 offen lds
    v_mfma_f32_16x16x32_bf16 v[52:55], v[140:143], v[152:155], v[52:55]
    s_waitcnt lgkmcnt(0)
    v_mfma_f32_16x16x32_bf16 v[84:87], v[112:115], v[112:115], v[84:87]
    ds_read_b64_tr_b16 v[148:149], v14 offset:36864
    v_smfmac_f32_16x16x64_bf16 v[88:91], v[80:83], v[112:119], v72
    ds_read_b64_tr_b16 v[150:151], v14 offset:37376
    buffer_load_dwordx4 v193, s[20:23], s74 offen offset:1024 lds
    v_smfmac_f32_16x16x64_bf16 v[76:79], v[80:83], v[120:127], v72
    ds_read_b64_tr_b16 v[152:153], v14 offset:45056
    v_mfma_f32_16x16x32_bf16 v[24:27], v[116:119], v[96:99], v[24:27]
    ds_read_b64_tr_b16 v[154:155], v14 offset:45568
    v_mfma_f32_16x16x32_bf16 v[28:31], v[116:119], v[100:103], v[28:31]
    ds_read_b64_tr_b16 v[156:157], v14 offset:53248
    buffer_load_dwordx4 v194, s[20:23], s74 offen offset:2048 lds
    v_mfma_f32_16x16x32_bf16 v[32:35], v[116:119], v[104:107], v[32:35]
    ds_read_b64_tr_b16 v[158:159], v14 offset:53760
    v_mfma_f32_16x16x32_bf16 v[36:39], v[116:119], v[108:111], v[36:39]
    ds_read_b128 v[128:131], v7 offset:32768
    v_mfma_f32_16x16x32_bf16 v[40:43], v[96:99], v[120:123], v[40:43]
    ds_read_b128 v[132:135], v7 offset:34816
    buffer_load_dwordx4 v195, s[20:23], s74 offen offset:3072 lds
    v_mfma_f32_16x16x32_bf16 v[56:59], v[96:99], v[124:127], v[56:59]
    ds_read_b128 v[136:139], v7 offset:36864
    v_mfma_f32_16x16x32_bf16 v[60:63], v[100:103], v[124:127], v[60:63]
    ds_read_b128 v[140:143], v7 offset:38912
    v_mfma_f32_16x16x32_bf16 v[44:47], v[100:103], v[120:123], v[44:47]
    ds_read_b128 v[144:147], v11 offset:32768
    v_mfma_f32_16x16x32_bf16 v[48:51], v[104:107], v[120:123], v[48:51]
    v_mfma_f32_16x16x32_bf16 v[64:67], v[104:107], v[124:127], v[64:67]
    v_mfma_f32_16x16x32_bf16 v[68:71], v[108:111], v[124:127], v[68:71]
    v_mfma_f32_16x16x32_bf16 v[52:55], v[108:111], v[120:123], v[52:55]
    s_waitcnt vmcnt(19)
    s_waitcnt lgkmcnt(0)
    s_barrier
    v_mfma_f32_16x16x32_bf16 v[84:87], v[144:147], v[144:147], v[84:87]
    ds_read_b64_tr_b16 v[116:117], v15 offset:0
    v_smfmac_f32_16x16x64_bf16 v[88:91], v[80:83], v[144:151], v72
    ds_read_b64_tr_b16 v[118:119], v15 offset:512
    s_bfe_u32 s76, s52, 0x40008
    s_mul_i32 s74, s76, 458752
    s_add_u32 m0, s78, 32768
    s_add_u32 s74, s74, s58
    buffer_load_dwordx4 v192, s[20:23], s74 offen lds
    v_smfmac_f32_16x16x64_bf16 v[76:79], v[80:83], v[152:159], v72
    ds_read_b64_tr_b16 v[120:121], v15 offset:8192
    v_mfma_f32_16x16x32_bf16 v[24:27], v[148:151], v[128:131], v[24:27]
    ds_read_b64_tr_b16 v[122:123], v15 offset:8704
    v_mfma_f32_16x16x32_bf16 v[28:31], v[148:151], v[132:135], v[28:31]
    ds_read_b64_tr_b16 v[124:125], v15 offset:16384
    buffer_load_dwordx4 v193, s[20:23], s74 offen offset:1024 lds
    v_mfma_f32_16x16x32_bf16 v[32:35], v[148:151], v[136:139], v[32:35]
    ds_read_b64_tr_b16 v[126:127], v15 offset:16896
    v_mfma_f32_16x16x32_bf16 v[36:39], v[148:151], v[140:143], v[36:39]
    ds_read_b128 v[96:99], v8 offset:0
    v_mfma_f32_16x16x32_bf16 v[40:43], v[128:131], v[152:155], v[40:43]
    ds_read_b128 v[100:103], v8 offset:2048
    buffer_load_dwordx4 v194, s[20:23], s74 offen offset:2048 lds
    v_mfma_f32_16x16x32_bf16 v[56:59], v[128:131], v[156:159], v[56:59]
    ds_read_b128 v[104:107], v8 offset:4096
    v_mfma_f32_16x16x32_bf16 v[60:63], v[132:135], v[156:159], v[60:63]
    ds_read_b128 v[108:111], v8 offset:6144
    v_mfma_f32_16x16x32_bf16 v[44:47], v[132:135], v[152:155], v[44:47]
    ds_read_b128 v[112:115], v12 offset:0
    buffer_load_dwordx4 v195, s[20:23], s74 offen offset:3072 lds
    v_mfma_f32_16x16x32_bf16 v[48:51], v[136:139], v[152:155], v[48:51]
    v_mfma_f32_16x16x32_bf16 v[64:67], v[136:139], v[156:159], v[64:67]
    v_mfma_f32_16x16x32_bf16 v[68:71], v[140:143], v[156:159], v[68:71]
    s_bfe_u32 s76, s52, 0x4000c
    s_mul_i32 s74, s76, 458752
    s_add_u32 m0, s78, 49152
    s_add_u32 s74, s74, s58
    buffer_load_dwordx4 v192, s[20:23], s74 offen lds
    v_mfma_f32_16x16x32_bf16 v[52:55], v[140:143], v[152:155], v[52:55]
    s_waitcnt lgkmcnt(0)
    s_lshl_b32 s4, s3, 10
    s_add_u32 s81, s4, 10223616
    buffer_load_dword v252, v219, s[28:31], s81 offen sc1
    v_mfma_f32_16x16x32_bf16 v[84:87], v[112:115], v[112:115], v[84:87]
    ds_read_b64_tr_b16 v[148:149], v15 offset:4096
    v_smfmac_f32_16x16x64_bf16 v[88:91], v[80:83], v[112:119], v72
    ds_read_b64_tr_b16 v[150:151], v15 offset:4608
    buffer_load_dwordx4 v193, s[20:23], s74 offen offset:1024 lds
    v_smfmac_f32_16x16x64_bf16 v[76:79], v[80:83], v[120:127], v72
    ds_read_b64_tr_b16 v[152:153], v15 offset:12288
    v_mfma_f32_16x16x32_bf16 v[24:27], v[116:119], v[96:99], v[24:27]
    ds_read_b64_tr_b16 v[154:155], v15 offset:12800
    v_mfma_f32_16x16x32_bf16 v[28:31], v[116:119], v[100:103], v[28:31]
    ds_read_b64_tr_b16 v[156:157], v15 offset:20480
    buffer_load_dwordx4 v194, s[20:23], s74 offen offset:2048 lds
    v_mfma_f32_16x16x32_bf16 v[32:35], v[116:119], v[104:107], v[32:35]
    ds_read_b64_tr_b16 v[158:159], v15 offset:20992
    v_mfma_f32_16x16x32_bf16 v[36:39], v[116:119], v[108:111], v[36:39]
    ds_read_b128 v[128:131], v9 offset:0
    v_mfma_f32_16x16x32_bf16 v[40:43], v[96:99], v[120:123], v[40:43]
    ds_read_b128 v[132:135], v9 offset:2048
    buffer_load_dwordx4 v195, s[20:23], s74 offen offset:3072 lds
    v_mfma_f32_16x16x32_bf16 v[56:59], v[96:99], v[124:127], v[56:59]
    ds_read_b128 v[136:139], v9 offset:4096
    v_mfma_f32_16x16x32_bf16 v[60:63], v[100:103], v[124:127], v[60:63]
    ds_read_b128 v[140:143], v9 offset:6144
    v_mfma_f32_16x16x32_bf16 v[44:47], v[100:103], v[120:123], v[44:47]
    ds_read_b128 v[144:147], v13 offset:0
    v_mfma_f32_16x16x32_bf16 v[48:51], v[104:107], v[120:123], v[48:51]
    v_mfma_f32_16x16x32_bf16 v[64:67], v[104:107], v[124:127], v[64:67]
    v_mfma_f32_16x16x32_bf16 v[68:71], v[108:111], v[124:127], v[68:71]
    v_mfma_f32_16x16x32_bf16 v[52:55], v[108:111], v[120:123], v[52:55]
    s_waitcnt vmcnt(20)
    s_waitcnt lgkmcnt(0)
    s_barrier
    v_mfma_f32_16x16x32_bf16 v[84:87], v[144:147], v[144:147], v[84:87]
    ds_read_b64_tr_b16 v[116:117], v15 offset:32768
    v_smfmac_f32_16x16x64_bf16 v[88:91], v[80:83], v[144:151], v72
    ds_read_b64_tr_b16 v[118:119], v15 offset:33280
    s_bfe_u32 s76, s52, 0x40010
    s_mul_i32 s74, s76, 458752
    s_add_u32 m0, s78, 65536
    s_add_u32 s74, s74, s58
    buffer_load_dwordx4 v192, s[20:23], s74 offen lds
    v_smfmac_f32_16x16x64_bf16 v[76:79], v[80:83], v[152:159], v72
    ds_read_b64_tr_b16 v[120:121], v15 offset:40960
    v_mfma_f32_16x16x32_bf16 v[24:27], v[148:151], v[128:131], v[24:27]
    ds_read_b64_tr_b16 v[122:123], v15 offset:41472
    v_mfma_f32_16x16x32_bf16 v[28:31], v[148:151], v[132:135], v[28:31]
    ds_read_b64_tr_b16 v[124:125], v15 offset:49152
    buffer_load_dwordx4 v193, s[20:23], s74 offen offset:1024 lds
    v_mfma_f32_16x16x32_bf16 v[32:35], v[148:151], v[136:139], v[32:35]
    ds_read_b64_tr_b16 v[126:127], v15 offset:49664
    v_mfma_f32_16x16x32_bf16 v[36:39], v[148:151], v[140:143], v[36:39]
    ds_read_b128 v[96:99], v8 offset:32768
    v_mfma_f32_16x16x32_bf16 v[40:43], v[128:131], v[152:155], v[40:43]
    ds_read_b128 v[100:103], v8 offset:34816
    buffer_load_dwordx4 v194, s[20:23], s74 offen offset:2048 lds
    v_mfma_f32_16x16x32_bf16 v[56:59], v[128:131], v[156:159], v[56:59]
    ds_read_b128 v[104:107], v8 offset:36864
    v_mfma_f32_16x16x32_bf16 v[60:63], v[132:135], v[156:159], v[60:63]
    ds_read_b128 v[108:111], v8 offset:38912
    v_mfma_f32_16x16x32_bf16 v[44:47], v[132:135], v[152:155], v[44:47]
    ds_read_b128 v[112:115], v12 offset:32768
    buffer_load_dwordx4 v195, s[20:23], s74 offen offset:3072 lds
    v_mfma_f32_16x16x32_bf16 v[48:51], v[136:139], v[152:155], v[48:51]
    v_mfma_f32_16x16x32_bf16 v[64:67], v[136:139], v[156:159], v[64:67]
    v_mfma_f32_16x16x32_bf16 v[68:71], v[140:143], v[156:159], v[68:71]
    s_bfe_u32 s76, s52, 0x40014
    s_mul_i32 s74, s76, 458752
    s_add_u32 m0, s78, 81920
    s_add_u32 s74, s74, s58
    buffer_load_dwordx4 v192, s[20:23], s74 offen lds
    v_mfma_f32_16x16x32_bf16 v[52:55], v[140:143], v[152:155], v[52:55]
    s_waitcnt lgkmcnt(0)
    v_mfma_f32_16x16x32_bf16 v[84:87], v[112:115], v[112:115], v[84:87]
    ds_read_b64_tr_b16 v[148:149], v15 offset:36864
    v_smfmac_f32_16x16x64_bf16 v[88:91], v[80:83], v[112:119], v72
    ds_read_b64_tr_b16 v[150:151], v15 offset:37376
    buffer_load_dwordx4 v193, s[20:23], s74 offen offset:1024 lds
    v_smfmac_f32_16x16x64_bf16 v[76:79], v[80:83], v[120:127], v72
L_w2:
    s_cbranch_execz L_w6
    ds_read_b64_tr_b16 v[152:153], v15 offset:45056
    v_mfma_f32_16x16x32_bf16 v[24:27], v[116:119], v[96:99], v[24:27]
    ds_read_b64_tr_b16 v[154:155], v15 offset:45568
    v_mfma_f32_16x16x32_bf16 v[28:31], v[116:119], v[100:103], v[28:31]
    ds_read_b64_tr_b16 v[156:157], v15 offset:53248
    buffer_load_dwordx4 v194, s[20:23], s74 offen offset:2048 lds
    v_mfma_f32_16x16x32_bf16 v[32:35], v[116:119], v[104:107], v[32:35]
    ds_read_b64_tr_b16 v[158:159], v15 offset:53760
    v_mfma_f32_16x16x32_bf16 v[36:39], v[116:119], v[108:111], v[36:39]
    ds_read_b128 v[128:131], v9 offset:32768
    v_mfma_f32_16x16x32_bf16 v[40:43], v[96:99], v[120:123], v[40:43]
    ds_read_b128 v[132:135], v9 offset:34816
    buffer_load_dwordx4 v195, s[20:23], s74 offen offset:3072 lds
    v_mfma_f32_16x16x32_bf16 v[56:59], v[96:99], v[124:127], v[56:59]
    ds_read_b128 v[136:139], v9 offset:36864
    v_mfma_f32_16x16x32_bf16 v[60:63], v[100:103], v[124:127], v[60:63]
    ds_read_b128 v[140:143], v9 offset:38912
    v_mfma_f32_16x16x32_bf16 v[44:47], v[100:103], v[120:123], v[44:47]
    ds_read_b128 v[144:147], v13 offset:32768
    v_mfma_f32_16x16x32_bf16 v[48:51], v[104:107], v[120:123], v[48:51]
    v_mfma_f32_16x16x32_bf16 v[64:67], v[104:107], v[124:127], v[64:67]
    v_mfma_f32_16x16x32_bf16 v[68:71], v[108:111], v[124:127], v[68:71]
    v_mfma_f32_16x16x32_bf16 v[52:55], v[108:111], v[120:123], v[52:55]
    s_waitcnt vmcnt(11)
    v_cmp_ne_u32 vcc, s64, v252
    s_cbranch_vccz L_okm2
    s_mov_b32 s79, 100000
L_okm2s:
    buffer_load_dword v252, v219, s[28:31], s81 offen sc1
    s_waitcnt vmcnt(0)
    v_cmp_ne_u32 vcc, s64, v252
    s_cbranch_vccz L_okm2
    s_sub_u32 s79, s79, 1
    s_cmp_lg_u32 s79, 0
    s_cbranch_scc1 L_okm2s
L_okm2:
    s_waitcnt lgkmcnt(0)
    s_barrier
    s_or_b32 s4, s2, s3
    s_cmp_lg_u32 s4, 0
    s_cbranch_scc1 L_epoch
    s_mov_b32 s4, 9957376
    s_mov_b64 exec, 1
    buffer_store_dword v180, off, s[28:31], s4 sc1
    s_mov_b32 s4, 11530240
    buffer_store_dword v180, off, s[28:31], s4 sc1
    s_mov_b64 exec, -1
L_epoch:
    v_mfma_f32_16x16x32_bf16 v[84:87], v[144:147], v[144:147], v[84:87]
    v_smfmac_f32_16x16x64_bf16 v[88:91], v[80:83], v[144:151], v72
    s_bfe_u32 s76, s52, 0x40000
    s_lshl_b32 s75, s76, 13
    s_add_u32 s75, s75, s61
    buffer_load_dwordx4 a[0:3], v1, s[28:31], s75 offen offset:0 sc1
    v_smfmac_f32_16x16x64_bf16 v[76:79], v[80:83], v[152:159], v72
    v_mfma_f32_16x16x32_bf16 v[24:27], v[148:151], v[128:131], v[24:27]
    v_mfma_f32_16x16x32_bf16 v[28:31], v[148:151], v[132:135], v[28:31]
    buffer_load_dwordx4 a[4:7], v1, s[28:31], s75 offen offset:1024 sc1
    v_mfma_f32_16x16x32_bf16 v[32:35], v[148:151], v[136:139], v[32:35]
    v_mfma_f32_16x16x32_bf16 v[36:39], v[148:151], v[140:143], v[36:39]
    v_mfma_f32_16x16x32_bf16 v[40:43], v[128:131], v[152:155], v[40:43]
    buffer_load_dwordx4 a[8:11], v1, s[28:31], s75 offen offset:2048 sc1
    v_mfma_f32_16x16x32_bf16 v[56:59], v[128:131], v[156:159], v[56:59]
    v_mfma_f32_16x16x32_bf16 v[60:63], v[132:135], v[156:159], v[60:63]
    v_mfma_f32_16x16x32_bf16 v[44:47], v[132:135], v[152:155], v[44:47]
    buffer_load_dwordx4 a[12:15], v1, s[28:31], s75 offen offset:3072 sc1
    v_mfma_f32_16x16x32_bf16 v[48:51], v[136:139], v[152:155], v[48:51]
    v_mfma_f32_16x16x32_bf16 v[64:67], v[136:139], v[156:159], v[64:67]
    v_mfma_f32_16x16x32_bf16 v[68:71], v[140:143], v[156:159], v[68:71]
    s_bfe_u32 s76, s52, 0x40004
    s_lshl_b32 s75, s76, 13
    s_add_u32 s75, s75, s61
    buffer_load_dwordx4 a[16:19], v1, s[28:31], s75 offen offset:0 sc1
    v_mfma_f32_16x16x32_bf16 v[52:55], v[140:143], v[152:155], v[52:55]
    s_mov_b32 s4, 0xaaaaaaaa
    s_mov_b32 s5, 0xaaaaaaaa
    s_mov_b32 s6, 0xcccccccc
    s_mov_b32 s7, 0xcccccccc
    v_and_b32 v16, 15, v0
    v_lshlrev_b32 v16, 2, v16
    v_add_u32 v16, 139264, v16
    v_lshl_add_u32 v17, s3, 6, v16
    v_and_b32 v18, 48, v0
    v_add_u32 v19, 139264, v18
    v_cndmask_b32 v98, v84, v85, s[4:5]
    v_cndmask_b32 v99, v86, v87, s[4:5]
    v_cndmask_b32 v96, v98, v99, s[6:7]
    v_add_f32 v97, v88, v89
    buffer_load_dwordx4 a[20:23], v1, s[28:31], s75 offen offset:1024 sc1
    v_add_f32 v98, v90, v91
    v_add_f32 v80, v78, v79
    v_add_f32 v81, v78, v79
    v_add_f32 v76, v76, v77
    v_mov_b32 v77, v76
    v_lshl_add_u32 v100, s3, 6, v19
    v_mul_f32 v97, 0xbb000000, v97
    v_mul_f32 v96, 0x3b000000, v96
    v_fma_f32 v96, -v97, v97, v96
    v_max_f32 v96, 0, v96
    buffer_load_dwordx4 a[24:27], v1, s[28:31], s75 offen offset:2048 sc1
    v_add_f32 v96, 0x3727c5ac, v96
    v_rsq_f32 v96, v96
    s_mov_b32 exec_lo, 0x00f0000f
    s_mov_b32 exec_hi, 0xf0000f00
    ds_write_b32 v17, v97
    ds_write_b32 v17, v98 offset:512
    ds_write_b32 v17, v96 offset:256
    s_mov_b64 exec, -1
    v_add_u32 v6, 0x10000, v204
    v_add_u32 v7, 0x10000, v205
    v_add_u32 v8, 0x10000, v206
    v_add_u32 v9, 0x10000, v207
    v_lshlrev_b32 v220, 16, v236
    v_and_b32 v221, 0xffff0000, v236
    v_lshlrev_b32 v222, 16, v237
    buffer_load_dwordx4 a[28:31], v1, s[28:31], s75 offen offset:3072 sc1
    v_and_b32 v223, 0xffff0000, v237
    v_lshlrev_b32 v224, 16, v236
    v_and_b32 v225, 0xffff0000, v236
    v_lshlrev_b32 v226, 16, v237
    v_and_b32 v227, 0xffff0000, v237
    v_lshlrev_b32 v228, 16, v238
    v_and_b32 v229, 0xffff0000, v238
    v_lshlrev_b32 v230, 16, v239
    v_and_b32 v231, 0xffff0000, v239
    v_lshlrev_b32 v232, 16, v238
    s_bfe_u32 s76, s52, 0x40008
    s_lshl_b32 s75, s76, 13
    s_add_u32 s75, s75, s61
    buffer_load_dwordx4 a[32:35], v1, s[28:31], s75 offen offset:0 sc1
    v_and_b32 v233, 0xffff0000, v238
    v_lshlrev_b32 v234, 16, v239
    v_and_b32 v235, 0xffff0000, v239
    s_waitcnt lgkmcnt(0)
    s_barrier
    ds_read_b128 v[108:111], v19 offset:0
    ds_read_b128 v[124:127], v19 offset:256
    ds_read_b128 v[112:115], v19 offset:64
    ds_read_b128 v[128:131], v19 offset:320
    ds_read_b128 v[116:119], v19 offset:128
    ds_read_b128 v[132:135], v19 offset:384
    ds_read_b128 v[120:123], v19 offset:192
    ds_read_b128 v[136:139], v19 offset:448
    ds_read_b128 v[72:75], v100 offset:512
    ds_read2_b32 v[88:89], v16 offset0:0 offset1:64
    ds_read2_b32 v[90:91], v16 offset0:16 offset1:80
    ds_read2_b32 v[92:93], v16 offset0:32 offset1:96
    ds_read2_b32 v[94:95], v16 offset0:48 offset1:112
    s_mov_b32 s86, 0x358637bd
    s_mov_b32 s87, 0x3fb8aa3b
    s_lshl_b32 s6, s45, 2
    s_add_u32 s6, s6, s3
    s_lshl_b32 s6, s6, 5
    s_add_u32 s6, s6, s44
    s_lshl_b32 s88, s6, 10
    s_add_u32 s88, s88, 8388608
    s_lshl_b32 s89, s6, 6
    s_add_u32 s89, s89, 9437184
    ds_read_b64_tr_b16 a[96:97], v204 offset:0
    ds_read_b64_tr_b16 a[98:99], v204 offset:512
    ds_read_b64_tr_b16 a[100:101], v205 offset:0
    ds_read_b64_tr_b16 a[102:103], v205 offset:512
    ds_read_b64_tr_b16 a[104:105], v206 offset:0
    ds_read_b64_tr_b16 a[106:107], v206 offset:512
    ds_read_b64_tr_b16 a[108:109], v207 offset:0
    ds_read_b64_tr_b16 a[110:111], v207 offset:512
    buffer_load_dwordx4 a[36:39], v1, s[28:31], s75 offen offset:1024 sc1
    ds_read_b64_tr_b16 a[112:113], v204 offset:4096
    ds_read_b64_tr_b16 a[114:115], v204 offset:4608
    ds_read_b64_tr_b16 a[116:117], v205 offset:4096
    ds_read_b64_tr_b16 a[118:119], v205 offset:4608
    ds_read_b64_tr_b16 a[120:121], v206 offset:4096
    ds_read_b64_tr_b16 a[122:123], v206 offset:4608
    ds_read_b64_tr_b16 a[124:125], v207 offset:4096
    ds_read_b64_tr_b16 a[126:127], v207 offset:4608
    buffer_load_dwordx4 a[40:43], v1, s[28:31], s75 offen offset:2048 sc1
    s_waitcnt lgkmcnt(15)
    v_pk_fma_f32 v[40:41], v[108:109], v[76:77], v[40:41]
    v_pk_fma_f32 v[42:43], v[110:111], v[76:77], v[42:43]
    v_pk_fma_f32 v[56:57], v[108:109], v[80:81], v[56:57]
    v_pk_fma_f32 v[58:59], v[110:111], v[80:81], v[58:59]
    v_pk_fma_f32 v[40:41], v[40:41], v[124:125], s[86:87] op_sel_hi:[1,1,0]
    v_pk_fma_f32 v[42:43], v[42:43], v[126:127], s[86:87] op_sel_hi:[1,1,0]
    v_pk_mul_f32 v[56:57], v[56:57], v[124:125]
    v_pk_mul_f32 v[58:59], v[58:59], v[126:127]
    v_cvt_pk_bf16_f32 v156, v56, v57
    v_cvt_pk_bf16_f32 v157, v58, v59
    buffer_load_dwordx4 a[44:47], v1, s[28:31], s75 offen offset:3072 sc1
    v_pk_mul_f32 v[140:141], v[40:41], s[86:87] op_sel:[0,1] op_sel_hi:[1,1]
    v_pk_mul_f32 v[142:143], v[42:43], s[86:87] op_sel:[0,1] op_sel_hi:[1,1]
    v_exp_f32_e64 v140, v140 clamp
    v_exp_f32_e64 v141, v141 clamp
    v_exp_f32_e64 v142, v142 clamp
    v_exp_f32_e64 v143, v143 clamp
    s_bfe_u32 s76, s52, 0x4000c
    s_lshl_b32 s75, s76, 13
    s_add_u32 s75, s75, s61
    buffer_load_dwordx4 a[48:51], v1, s[28:31], s75 offen offset:0 sc1
    v_max_f32 v40, s86, v40
    v_max_f32 v41, s86, v41
    v_max_f32 v42, s86, v42
    v_max_f32 v43, s86, v43
    v_pk_add_f32 v[40:41], v[40:41], v[140:141]
    v_pk_add_f32 v[42:43], v[42:43], v[142:143]
    v_cvt_pk_bf16_f32 v148, v40, v41
    v_cvt_pk_bf16_f32 v149, v42, v43
    v_pk_fma_f32 v[44:45], v[112:113], v[76:77], v[44:45]
    v_pk_fma_f32 v[46:47], v[114:115], v[76:77], v[46:47]
    buffer_load_dwordx4 a[52:55], v1, s[28:31], s75 offen offset:1024 sc1
    v_pk_fma_f32 v[60:61], v[112:113], v[80:81], v[60:61]
    v_pk_fma_f32 v[62:63], v[114:115], v[80:81], v[62:63]
    v_pk_fma_f32 v[44:45], v[44:45], v[128:129], s[86:87] op_sel_hi:[1,1,0]
    v_pk_fma_f32 v[46:47], v[46:47], v[130:131], s[86:87] op_sel_hi:[1,1,0]
    v_pk_mul_f32 v[60:61], v[60:61], v[128:129]
    v_pk_mul_f32 v[62:63], v[62:63], v[130:131]
    v_cvt_pk_bf16_f32 v158, v60, v61
    v_cvt_pk_bf16_f32 v159, v62, v63
    v_pk_mul_f32 v[140:141], v[44:45], s[86:87] op_sel:[0,1] op_sel_hi:[1,1]
    v_pk_mul_f32 v[142:143], v[46:47], s[86:87] op_sel:[0,1] op_sel_hi:[1,1]
    buffer_load_dwordx4 a[56:59], v1, s[28:31], s75 offen offset:2048 sc1
    v_exp_f32_e64 v140, v140 clamp
    v_exp_f32_e64 v141, v141 clamp
    v_exp_f32_e64 v142, v142 clamp
    v_exp_f32_e64 v143, v143 clamp
    v_max_f32 v44, s86, v44
    v_max_f32 v45, s86, v45
    buffer_load_dwordx4 a[60:63], v1, s[28:31], s75 offen offset:3072 sc1
    v_max_f32 v46, s86, v46
    v_max_f32 v47, s86, v47
    v_pk_add_f32 v[44:45], v[44:45], v[140:141]
    v_pk_add_f32 v[46:47], v[46:47], v[142:143]
    v_cvt_pk_bf16_f32 v150, v44, v45
    v_cvt_pk_bf16_f32 v151, v46, v47
    v_pk_fma_f32 v[48:49], v[116:117], v[76:77], v[48:49]
    v_pk_fma_f32 v[50:51], v[118:119], v[76:77], v[50:51]
    v_pk_fma_f32 v[64:65], v[116:117], v[80:81], v[64:65]
    v_pk_fma_f32 v[66:67], v[118:119], v[80:81], v[66:67]
    s_bfe_u32 s76, s52, 0x40010
    s_lshl_b32 s75, s76, 13
    s_add_u32 s75, s75, s61
    buffer_load_dwordx4 a[64:67], v1, s[28:31], s75 offen offset:0 sc1
    v_pk_fma_f32 v[48:49], v[48:49], v[132:133], s[86:87] op_sel_hi:[1,1,0]
    v_pk_fma_f32 v[50:51], v[50:51], v[134:135], s[86:87] op_sel_hi:[1,1,0]
    v_pk_mul_f32 v[64:65], v[64:65], v[132:133]
    v_pk_mul_f32 v[66:67], v[66:67], v[134:135]
    v_cvt_pk_bf16_f32 v160, v64, v65
    v_cvt_pk_bf16_f32 v161, v66, v67
    v_pk_mul_f32 v[140:141], v[48:49], s[86:87] op_sel:[0,1] op_sel_hi:[1,1]
    v_pk_mul_f32 v[142:143], v[50:51], s[86:87] op_sel:[0,1] op_sel_hi:[1,1]
    v_exp_f32_e64 v140, v140 clamp
    buffer_load_dwordx4 a[68:71], v1, s[28:31], s75 offen offset:1024 sc1
    v_exp_f32_e64 v141, v141 clamp
    v_exp_f32_e64 v142, v142 clamp
    v_exp_f32_e64 v143, v143 clamp
    v_max_f32 v48, s86, v48
    v_max_f32 v49, s86, v49
    v_max_f32 v50, s86, v50
    v_max_f32 v51, s86, v51
    buffer_load_dwordx4 a[72:75], v1, s[28:31], s75 offen offset:2048 sc1
    v_pk_add_f32 v[48:49], v[48:49], v[140:141]
    v_pk_add_f32 v[50:51], v[50:51], v[142:143]
    v_cvt_pk_bf16_f32 v152, v48, v49
    v_cvt_pk_bf16_f32 v153, v50, v51
    v_pk_fma_f32 v[52:53], v[120:121], v[76:77], v[52:53]
    v_pk_fma_f32 v[54:55], v[122:123], v[76:77], v[54:55]
    v_pk_fma_f32 v[68:69], v[120:121], v[80:81], v[68:69]
    v_pk_fma_f32 v[70:71], v[122:123], v[80:81], v[70:71]
    v_pk_fma_f32 v[52:53], v[52:53], v[136:137], s[86:87] op_sel_hi:[1,1,0]
    v_pk_fma_f32 v[54:55], v[54:55], v[138:139], s[86:87] op_sel_hi:[1,1,0]
    buffer_load_dwordx4 a[76:79], v1, s[28:31], s75 offen offset:3072 sc1
    v_pk_mul_f32 v[68:69], v[68:69], v[136:137]
    v_pk_mul_f32 v[70:71], v[70:71], v[138:139]
    v_cvt_pk_bf16_f32 v162, v68, v69
    v_cvt_pk_bf16_f32 v163, v70, v71
    v_pk_mul_f32 v[140:141], v[52:53], s[86:87] op_sel:[0,1] op_sel_hi:[1,1]
    v_pk_mul_f32 v[142:143], v[54:55], s[86:87] op_sel:[0,1] op_sel_hi:[1,1]
    v_exp_f32_e64 v140, v140 clamp
    v_exp_f32_e64 v141, v141 clamp
    s_bfe_u32 s76, s52, 0x40014
    s_lshl_b32 s75, s76, 13
    s_add_u32 s75, s75, s61
    buffer_load_dwordx4 a[80:83], v1, s[28:31], s75 offen offset:0 sc1
    v_exp_f32_e64 v142, v142 clamp
    v_exp_f32_e64 v143, v143 clamp
    v_max_f32 v52, s86, v52
    v_max_f32 v53, s86, v53
    v_max_f32 v54, s86, v54
    v_max_f32 v55, s86, v55
    v_pk_add_f32 v[52:53], v[52:53], v[140:141]
    v_pk_add_f32 v[54:55], v[54:55], v[142:143]
    buffer_load_dwordx4 a[84:87], v1, s[28:31], s75 offen offset:1024 sc1
    v_cvt_pk_bf16_f32 v154, v52, v53
    v_cvt_pk_bf16_f32 v155, v54, v55
    v_pk_fma_f32 v[24:25], v[88:89], v[72:73], v[24:25] op_sel_hi:[0,1,1]
    v_pk_fma_f32 v[26:27], v[88:89], v[74:75], v[26:27] op_sel_hi:[0,1,1]
    v_mfma_f32_16x16x32_bf16 v[172:175], v[148:151], v[156:159], 0
    v_mfma_f32_16x16x32_bf16 v[176:179], v[148:151], v[20:23], 0
    v_mfma_f32_16x16x32_bf16 v[172:175], v[152:155], v[160:163], v[172:175]
    v_mfma_f32_16x16x32_bf16 v[176:179], v[152:155], v[20:23], v[176:179]
    v_pk_fma_f32 v[24:25], v[24:25], v[88:89], s[86:87] op_sel:[0,1,0] op_sel_hi:[1,1,0]
    v_pk_fma_f32 v[26:27], v[26:27], v[88:89], s[86:87] op_sel:[0,1,0] op_sel_hi:[1,1,0]
    buffer_load_dwordx4 a[88:91], v1, s[28:31], s75 offen offset:2048 sc1
    s_nop 3
    buffer_store_dwordx4 v[172:175], v1, s[28:31], s88 offen sc1
    s_mov_b32 exec_lo, 0x00010001
    s_mov_b32 exec_hi, 0x00010001
    buffer_store_dwordx4 v[176:179], v18, s[28:31], s89 offen sc1
    s_mov_b64 exec, -1
    s_lshl_b32 s82, s45, 5
    s_add_u32 s82, s82, s44
    s_barrier
    s_waitcnt vmcnt(23)
    s_waitcnt lgkmcnt(8)
    v_mfma_f32_16x16x32_bf16 v[220:223], a[96:99], a[0:3], v[220:223]
    ds_read_b64_tr_b16 a[128:129], v204 offset:16384
    v_mfma_f32_16x16x32_bf16 v[224:227], a[96:99], a[4:7], v[224:227]
    ds_read_b64_tr_b16 a[130:131], v204 offset:16896
    buffer_load_dwordx4 a[92:95], v1, s[28:31], s75 offen offset:3072 sc1
    v_mfma_f32_16x16x32_bf16 v[228:231], a[100:103], a[0:3], v[228:231]
    ds_read_b64_tr_b16 a[132:133], v205 offset:16384
    v_mfma_f32_16x16x32_bf16 v[232:235], a[100:103], a[4:7], v[232:235]
    ds_read_b64_tr_b16 a[134:135], v205 offset:16896
    s_bfe_u32 s76, s52, 0x40018
    s_mul_i32 s74, s76, 458752
    s_add_u32 m0, s78, 98304
    s_add_u32 s74, s74, s58
    buffer_load_dwordx4 v192, s[20:23], s74 offen lds
    v_mfma_f32_16x16x32_bf16 v[236:239], a[104:107], a[0:3], 0
    ds_read_b64_tr_b16 a[136:137], v206 offset:16384
    v_mfma_f32_16x16x32_bf16 v[240:243], a[104:107], a[4:7], 0
    ds_read_b64_tr_b16 a[138:139], v206 offset:16896
    v_mfma_f32_16x16x32_bf16 v[244:247], a[108:111], a[0:3], 0
    ds_read_b64_tr_b16 a[140:141], v207 offset:16384
    v_mfma_f32_16x16x32_bf16 v[248:251], a[108:111], a[4:7], 0
    ds_read_b64_tr_b16 a[142:143], v207 offset:16896
    buffer_load_dwordx4 v193, s[20:23], s74 offen offset:1024 lds
    s_waitcnt vmcnt(24)
    s_waitcnt lgkmcnt(8)
    v_mfma_f32_16x16x32_bf16 v[220:223], a[112:115], a[8:11], v[220:223]
    ds_read_b64_tr_b16 a[144:145], v204 offset:20480
    v_mfma_f32_16x16x32_bf16 v[224:227], a[112:115], a[12:15], v[224:227]
    ds_read_b64_tr_b16 a[146:147], v204 offset:20992
    buffer_load_dwordx4 v194, s[20:23], s74 offen offset:2048 lds
    v_mfma_f32_16x16x32_bf16 v[228:231], a[116:119], a[8:11], v[228:231]
    ds_read_b64_tr_b16 a[148:149], v205 offset:20480
    v_mfma_f32_16x16x32_bf16 v[232:235], a[116:119], a[12:15], v[232:235]
    ds_read_b64_tr_b16 a[150:151], v205 offset:20992
    v_mfma_f32_16x16x32_bf16 v[236:239], a[120:123], a[8:11], v[236:239]
    ds_read_b64_tr_b16 a[152:153], v206 offset:20480
    v_mfma_f32_16x16x32_bf16 v[240:243], a[120:123], a[12:15], v[240:243]
    ds_read_b64_tr_b16 a[154:155], v206 offset:20992
    buffer_load_dwordx4 v195, s[20:23], s74 offen offset:3072 lds
    v_mfma_f32_16x16x32_bf16 v[244:247], a[124:127], a[8:11], v[244:247]
    ds_read_b64_tr_b16 a[156:157], v207 offset:20480
    v_mfma_f32_16x16x32_bf16 v[248:251], a[124:127], a[12:15], v[248:251]
    ds_read_b64_tr_b16 a[158:159], v207 offset:20992
    s_bfe_u32 s76, s52, 0x40018
    s_lshl_b32 s75, s76, 13
    s_add_u32 s75, s75, s61
    buffer_load_dwordx4 a[0:3], v1, s[28:31], s75 offen offset:0 sc1
    buffer_load_dwordx4 a[4:7], v1, s[28:31], s75 offen offset:1024 sc1
    buffer_load_dwordx4 a[8:11], v1, s[28:31], s75 offen offset:2048 sc1
    buffer_load_dwordx4 a[12:15], v1, s[28:31], s75 offen offset:3072 sc1
    s_bfe_u32 s76, s52, 0x4001c
    s_mul_i32 s74, s76, 458752
    s_add_u32 m0, s78, 114688
    s_add_u32 s74, s74, s58
    buffer_load_dwordx4 v192, s[20:23], s74 offen lds
    s_waitcnt vmcnt(10)
    s_barrier
    s_cmp_lg_u32 s3, 0
    s_cbranch_scc1 L_sigm3
    s_lshl_b32 s4, s82, 7
    s_add_u32 s4, s4, 10485760
    s_mov_b64 exec, 0xff
    buffer_store_dwordx4 v[180:183], v253, s[28:31], s4 offen sc1
    s_mov_b64 exec, -1
L_sigm3:
    s_waitcnt lgkmcnt(8)
    v_mfma_f32_16x16x32_bf16 v[220:223], a[128:131], a[16:19], v[220:223]
    ds_read_b64_tr_b16 a[96:97], v204 offset:32768
    v_mfma_f32_16x16x32_bf16 v[224:227], a[128:131], a[20:23], v[224:227]
    ds_read_b64_tr_b16 a[98:99], v204 offset:33280
    buffer_load_dwordx4 v193, s[20:23], s74 offen offset:1024 lds
    v_mfma_f32_16x16x32_bf16 v[228:231], a[132:135], a[16:19], v[228:231]
    ds_read_b64_tr_b16 a[100:101], v205 offset:32768
    v_mfma_f32_16x16x32_bf16 v[232:235], a[132:135], a[20:23], v[232:235]
    ds_read_b64_tr_b16 a[102:103], v205 offset:33280
    buffer_load_dwordx4 v194, s[20:23], s74 offen offset:2048 lds
    v_mfma_f32_16x16x32_bf16 v[236:239], a[136:139], a[16:19], v[236:239]
    ds_read_b64_tr_b16 a[104:105], v206 offset:32768
    v_mfma_f32_16x16x32_bf16 v[240:243], a[136:139], a[20:23], v[240:243]
    ds_read_b64_tr_b16 a[106:107], v206 offset:33280
    v_mfma_f32_16x16x32_bf16 v[244:247], a[140:143], a[16:19], v[244:247]
    ds_read_b64_tr_b16 a[108:109], v207 offset:32768
    v_mfma_f32_16x16x32_bf16 v[248:251], a[140:143], a[20:23], v[248:251]
    ds_read_b64_tr_b16 a[110:111], v207 offset:33280
    buffer_load_dwordx4 v195, s[20:23], s74 offen offset:3072 lds
    s_waitcnt lgkmcnt(8)
    v_mfma_f32_16x16x32_bf16 v[220:223], a[144:147], a[24:27], v[220:223]
    ds_read_b64_tr_b16 a[112:113], v204 offset:36864
    v_mfma_f32_16x16x32_bf16 v[224:227], a[144:147], a[28:31], v[224:227]
    ds_read_b64_tr_b16 a[114:115], v204 offset:37376
    s_bfe_u32 s76, s53, 0x40000
    s_mul_i32 s74, s76, 458752
    s_add_u32 m0, s78, 0
    s_add_u32 s74, s74, s58
    buffer_load_dwordx4 v192, s[20:23], s74 offen lds
    v_mfma_f32_16x16x32_bf16 v[228:231], a[148:151], a[24:27], v[228:231]
    ds_read_b64_tr_b16 a[116:117], v205 offset:36864
    v_mfma_f32_16x16x32_bf16 v[232:235], a[148:151], a[28:31], v[232:235]
    ds_read_b64_tr_b16 a[118:119], v205 offset:37376
    v_mfma_f32_16x16x32_bf16 v[236:239], a[152:155], a[24:27], v[236:239]
    ds_read_b64_tr_b16 a[120:121], v206 offset:36864
    v_mfma_f32_16x16x32_bf16 v[240:243], a[152:155], a[28:31], v[240:243]
    ds_read_b64_tr_b16 a[122:123], v206 offset:37376
    buffer_load_dwordx4 v193, s[20:23], s74 offen offset:1024 lds
    v_mfma_f32_16x16x32_bf16 v[244:247], a[156:159], a[24:27], v[244:247]
    ds_read_b64_tr_b16 a[124:125], v207 offset:36864
    v_mfma_f32_16x16x32_bf16 v[248:251], a[156:159], a[28:31], v[248:251]
    ds_read_b64_tr_b16 a[126:127], v207 offset:37376
    s_barrier
    s_waitcnt lgkmcnt(8)
    v_mfma_f32_16x16x32_bf16 v[220:223], a[96:99], a[32:35], v[220:223]
    ds_read_b64_tr_b16 a[128:129], v204 offset:49152
    v_mfma_f32_16x16x32_bf16 v[224:227], a[96:99], a[36:39], v[224:227]
    ds_read_b64_tr_b16 a[130:131], v204 offset:49664
    s_bfe_u32 s76, s52, 0x4001c
    s_lshl_b32 s75, s76, 13
    s_add_u32 s75, s75, s61
    buffer_load_dwordx4 a[16:19], v1, s[28:31], s75 offen offset:0 sc1
    v_mfma_f32_16x16x32_bf16 v[228:231], a[100:103], a[32:35], v[228:231]
    ds_read_b64_tr_b16 a[132:133], v205 offset:49152
    v_mfma_f32_16x16x32_bf16 v[232:235], a[100:103], a[36:39], v[232:235]
    ds_read_b64_tr_b16 a[134:135], v205 offset:49664
    buffer_load_dwordx4 a[20:23], v1, s[28:31], s75 offen offset:1024 sc1
    v_mfma_f32_16x16x32_bf16 v[236:239], a[104:107], a[32:35], v[236:239]
    ds_read_b64_tr_b16 a[136:137], v206 offset:49152
    v_mfma_f32_16x16x32_bf16 v[240:243], a[104:107], a[36:39], v[240:243]
    ds_read_b64_tr_b16 a[138:139], v206 offset:49664
    v_mfma_f32_16x16x32_bf16 v[244:247], a[108:111], a[32:35], v[244:247]
    ds_read_b64_tr_b16 a[140:141], v207 offset:49152
    v_mfma_f32_16x16x32_bf16 v[248:251], a[108:111], a[36:39], v[248:251]
    ds_read_b64_tr_b16 a[142:143], v207 offset:49664
    buffer_load_dwordx4 a[24:27], v1, s[28:31], s75 offen offset:2048 sc1
    s_waitcnt lgkmcnt(8)
    v_mfma_f32_16x16x32_bf16 v[220:223], a[112:115], a[40:43], v[220:223]
    ds_read_b64_tr_b16 a[144:145], v204 offset:53248
    v_mfma_f32_16x16x32_bf16 v[224:227], a[112:115], a[44:47], v[224:227]
    ds_read_b64_tr_b16 a[146:147], v204 offset:53760
    buffer_load_dwordx4 a[28:31], v1, s[28:31], s75 offen offset:3072 sc1
    v_mfma_f32_16x16x32_bf16 v[228:231], a[116:119], a[40:43], v[228:231]
    ds_read_b64_tr_b16 a[148:149], v205 offset:53248
    v_mfma_f32_16x16x32_bf16 v[232:235], a[116:119], a[44:47], v[232:235]
    ds_read_b64_tr_b16 a[150:151], v205 offset:53760
    v_mfma_f32_16x16x32_bf16 v[236:239], a[120:123], a[40:43], v[236:239]
    ds_read_b64_tr_b16 a[152:153], v206 offset:53248
    v_mfma_f32_16x16x32_bf16 v[240:243], a[120:123], a[44:47], v[240:243]
    ds_read_b64_tr_b16 a[154:155], v206 offset:53760
    buffer_load_dwordx4 v194, s[20:23], s74 offen offset:2048 lds
    v_mfma_f32_16x16x32_bf16 v[244:247], a[124:127], a[40:43], v[244:247]
    ds_read_b64_tr_b16 a[156:157], v207 offset:53248
    v_mfma_f32_16x16x32_bf16 v[248:251], a[124:127], a[44:47], v[248:251]
    ds_read_b64_tr_b16 a[158:159], v207 offset:53760
    s_barrier
    s_waitcnt lgkmcnt(8)
    v_mfma_f32_16x16x32_bf16 v[220:223], a[128:131], a[48:51], v[220:223]
    ds_read_b64_tr_b16 a[96:97], v6 offset:0
    v_mfma_f32_16x16x32_bf16 v[224:227], a[128:131], a[52:55], v[224:227]
    ds_read_b64_tr_b16 a[98:99], v6 offset:512
    s_bfe_u32 s76, s53, 0x40000
    s_lshl_b32 s75, s76, 13
    s_add_u32 s75, s75, s61
    buffer_load_dwordx4 a[32:35], v1, s[28:31], s75 offen offset:0 sc1
    v_mfma_f32_16x16x32_bf16 v[228:231], a[132:135], a[48:51], v[228:231]
    ds_read_b64_tr_b16 a[100:101], v7 offset:0
    v_mfma_f32_16x16x32_bf16 v[232:235], a[132:135], a[52:55], v[232:235]
    ds_read_b64_tr_b16 a[102:103], v7 offset:512
    buffer_load_dwordx4 a[36:39], v1, s[28:31], s75 offen offset:1024 sc1
    v_mfma_f32_16x16x32_bf16 v[236:239], a[136:139], a[48:51], v[236:239]
    ds_read_b64_tr_b16 a[104:105], v8 offset:0
    v_mfma_f32_16x16x32_bf16 v[240:243], a[136:139], a[52:55], v[240:243]
    ds_read_b64_tr_b16 a[106:107], v8 offset:512
    v_mfma_f32_16x16x32_bf16 v[244:247], a[140:143], a[48:51], v[244:247]
    ds_read_b64_tr_b16 a[108:109], v9 offset:0
    v_mfma_f32_16x16x32_bf16 v[248:251], a[140:143], a[52:55], v[248:251]
    ds_read_b64_tr_b16 a[110:111], v9 offset:512
    buffer_load_dwordx4 a[40:43], v1, s[28:31], s75 offen offset:2048 sc1
    s_waitcnt lgkmcnt(8)
    v_mfma_f32_16x16x32_bf16 v[220:223], a[144:147], a[56:59], v[220:223]
    ds_read_b64_tr_b16 a[112:113], v6 offset:4096
    v_mfma_f32_16x16x32_bf16 v[224:227], a[144:147], a[60:63], v[224:227]
    ds_read_b64_tr_b16 a[114:115], v6 offset:4608
    buffer_load_dwordx4 v195, s[20:23], s74 offen offset:3072 lds
    v_mfma_f32_16x16x32_bf16 v[228:231], a[148:151], a[56:59], v[228:231]
    ds_read_b64_tr_b16 a[116:117], v7 offset:4096
    v_mfma_f32_16x16x32_bf16 v[232:235], a[148:151], a[60:63], v[232:235]
    ds_read_b64_tr_b16 a[118:119], v7 offset:4608
    v_mfma_f32_16x16x32_bf16 v[236:239], a[152:155], a[56:59], v[236:239]
    ds_read_b64_tr_b16 a[120:121], v8 offset:4096
    v_mfma_f32_16x16x32_bf16 v[240:243], a[152:155], a[60:63], v[240:243]
    ds_read_b64_tr_b16 a[122:123], v8 offset:4608
    buffer_load_dwordx4 a[44:47], v1, s[28:31], s75 offen offset:3072 sc1
    v_mfma_f32_16x16x32_bf16 v[244:247], a[156:159], a[56:59], v[244:247]
    ds_read_b64_tr_b16 a[124:125], v9 offset:4096
    v_mfma_f32_16x16x32_bf16 v[248:251], a[156:159], a[60:63], v[248:251]
    ds_read_b64_tr_b16 a[126:127], v9 offset:4608
    s_barrier
    s_waitcnt lgkmcnt(8)
    v_mfma_f32_16x16x32_bf16 v[220:223], a[96:99], a[64:67], v[220:223]
    ds_read_b64_tr_b16 a[128:129], v6 offset:16384
    v_mfma_f32_16x16x32_bf16 v[224:227], a[96:99], a[68:71], v[224:227]
    ds_read_b64_tr_b16 a[130:131], v6 offset:16896
    s_bfe_u32 s76, s53, 0x40004
    s_mul_i32 s74, s76, 458752
    s_add_u32 m0, s78, 16384
    s_add_u32 s74, s74, s58
    buffer_load_dwordx4 v192, s[20:23], s74 offen lds
    v_mfma_f32_16x16x32_bf16 v[228:231], a[100:103], a[64:67], v[228:231]
    ds_read_b64_tr_b16 a[132:133], v7 offset:16384
    v_mfma_f32_16x16x32_bf16 v[232:235], a[100:103], a[68:71], v[232:235]
    ds_read_b64_tr_b16 a[134:135], v7 offset:16896
    s_bfe_u32 s76, s53, 0x40004
    s_lshl_b32 s75, s76, 13
    s_add_u32 s75, s75, s61
    buffer_load_dwordx4 a[48:51], v1, s[28:31], s75 offen offset:0 sc1
    v_mfma_f32_16x16x32_bf16 v[236:239], a[104:107], a[64:67], v[236:239]
    ds_read_b64_tr_b16 a[136:137], v8 offset:16384
    v_mfma_f32_16x16x32_bf16 v[240:243], a[104:107], a[68:71], v[240:243]
    ds_read_b64_tr_b16 a[138:139], v8 offset:16896
    v_mfma_f32_16x16x32_bf16 v[244:247], a[108:111], a[64:67], v[244:247]
    ds_read_b64_tr_b16 a[140:141], v9 offset:16384
    v_mfma_f32_16x16x32_bf16 v[248:251], a[108:111], a[68:71], v[248:251]
    ds_read_b64_tr_b16 a[142:143], v9 offset:16896
    buffer_load_dwordx4 v193, s[20:23], s74 offen offset:1024 lds
    s_waitcnt lgkmcnt(8)
    v_mfma_f32_16x16x32_bf16 v[220:223], a[112:115], a[72:75], v[220:223]
    ds_read_b64_tr_b16 a[144:145], v6 offset:20480
    v_mfma_f32_16x16x32_bf16 v[224:227], a[112:115], a[76:79], v[224:227]
    ds_read_b64_tr_b16 a[146:147], v6 offset:20992
    buffer_load_dwordx4 a[52:55], v1, s[28:31], s75 offen offset:1024 sc1
    v_mfma_f32_16x16x32_bf16 v[228:231], a[116:119], a[72:75], v[228:231]
    ds_read_b64_tr_b16 a[148:149], v7 offset:20480
    v_mfma_f32_16x16x32_bf16 v[232:235], a[116:119], a[76:79], v[232:235]
    ds_read_b64_tr_b16 a[150:151], v7 offset:20992
    v_mfma_f32_16x16x32_bf16 v[236:239], a[120:123], a[72:75], v[236:239]
    ds_read_b64_tr_b16 a[152:153], v8 offset:20480
    v_mfma_f32_16x16x32_bf16 v[240:243], a[120:123], a[76:79], v[240:243]
    ds_read_b64_tr_b16 a[154:155], v8 offset:20992
    buffer_load_dwordx4 v194, s[20:23], s74 offen offset:2048 lds
    v_mfma_f32_16x16x32_bf16 v[244:247], a[124:127], a[72:75], v[244:247]
    ds_read_b64_tr_b16 a[156:157], v9 offset:20480
    v_mfma_f32_16x16x32_bf16 v[248:251], a[124:127], a[76:79], v[248:251]
    ds_read_b64_tr_b16 a[158:159], v9 offset:20992
    s_waitcnt vmcnt(25)
    s_barrier
    s_waitcnt lgkmcnt(8)
    v_mfma_f32_16x16x32_bf16 v[220:223], a[128:131], a[80:83], v[220:223]
    ds_read_b64_tr_b16 a[96:97], v6 offset:32768
    v_mfma_f32_16x16x32_bf16 v[224:227], a[128:131], a[84:87], v[224:227]
    ds_read_b64_tr_b16 a[98:99], v6 offset:33280
    buffer_load_dwordx4 a[56:59], v1, s[28:31], s75 offen offset:2048 sc1
    v_mfma_f32_16x16x32_bf16 v[228:231], a[132:135], a[80:83], v[228:231]
    ds_read_b64_tr_b16 a[100:101], v7 offset:32768
    v_mfma_f32_16x16x32_bf16 v[232:235], a[132:135], a[84:87], v[232:235]
    ds_read_b64_tr_b16 a[102:103], v7 offset:33280
    buffer_load_dwordx4 v195, s[20:23], s74 offen offset:3072 lds
    v_mfma_f32_16x16x32_bf16 v[236:239], a[136:139], a[80:83], v[236:239]
    ds_read_b64_tr_b16 a[104:105], v8 offset:32768
    v_mfma_f32_16x16x32_bf16 v[240:243], a[136:139], a[84:87], v[240:243]
    ds_read_b64_tr_b16 a[106:107], v8 offset:33280
    v_mfma_f32_16x16x32_bf16 v[244:247], a[140:143], a[80:83], v[244:247]
    ds_read_b64_tr_b16 a[108:109], v9 offset:32768
L_w3:
    s_cbranch_execz L_w7
    v_mfma_f32_16x16x32_bf16 v[248:251], a[140:143], a[84:87], v[248:251]
    ds_read_b64_tr_b16 a[110:111], v9 offset:33280
    buffer_load_dwordx4 a[60:63], v1, s[28:31], s75 offen offset:3072 sc1
    s_waitcnt lgkmcnt(8)
    v_mfma_f32_16x16x32_bf16 v[220:223], a[144:147], a[88:91], v[220:223]
    ds_read_b64_tr_b16 a[112:113], v6 offset:36864
    v_mfma_f32_16x16x32_bf16 v[224:227], a[144:147], a[92:95], v[224:227]
    ds_read_b64_tr_b16 a[114:115], v6 offset:37376
    s_bfe_u32 s76, s53, 0x40008
    s_mul_i32 s74, s76, 458752
    s_add_u32 m0, s78, 32768
    s_add_u32 s74, s74, s58
    buffer_load_dwordx4 v192, s[20:23], s74 offen lds
    v_mfma_f32_16x16x32_bf16 v[228:231], a[148:151], a[88:91], v[228:231]
    ds_read_b64_tr_b16 a[116:117], v7 offset:36864
    v_mfma_f32_16x16x32_bf16 v[232:235], a[148:151], a[92:95], v[232:235]
    ds_read_b64_tr_b16 a[118:119], v7 offset:37376
    v_mfma_f32_16x16x32_bf16 v[236:239], a[152:155], a[88:91], v[236:239]
    ds_read_b64_tr_b16 a[120:121], v8 offset:36864
    v_mfma_f32_16x16x32_bf16 v[240:243], a[152:155], a[92:95], v[240:243]
    ds_read_b64_tr_b16 a[122:123], v8 offset:37376
    s_bfe_u32 s76, s53, 0x40008
    s_lshl_b32 s75, s76, 13
    s_add_u32 s75, s75, s61
    buffer_load_dwordx4 a[64:67], v1, s[28:31], s75 offen offset:0 sc1
    v_mfma_f32_16x16x32_bf16 v[244:247], a[156:159], a[88:91], v[244:247]
    ds_read_b64_tr_b16 a[124:125], v9 offset:36864
    v_mfma_f32_16x16x32_bf16 v[248:251], a[156:159], a[92:95], v[248:251]
    ds_read_b64_tr_b16 a[126:127], v9 offset:37376
    s_waitcnt vmcnt(22)
    s_barrier
    s_waitcnt lgkmcnt(8)
    v_mfma_f32_16x16x32_bf16 v[220:223], a[96:99], a[0:3], v[220:223]
    ds_read_b64_tr_b16 a[128:129], v6 offset:49152
    v_mfma_f32_16x16x32_bf16 v[224:227], a[96:99], a[4:7], v[224:227]
    ds_read_b64_tr_b16 a[130:131], v6 offset:49664
    buffer_load_dwordx4 v193, s[20:23], s74 offen offset:1024 lds
    v_mfma_f32_16x16x32_bf16 v[228:231], a[100:103], a[0:3], v[228:231]
    ds_read_b64_tr_b16 a[132:133], v7 offset:49152
    v_mfma_f32_16x16x32_bf16 v[232:235], a[100:103], a[4:7], v[232:235]
    ds_read_b64_tr_b16 a[134:135], v7 offset:49664
    buffer_load_dwordx4 a[68:71], v1, s[28:31], s75 offen offset:1024 sc1
    v_mfma_f32_16x16x32_bf16 v[236:239], a[104:107], a[0:3], v[236:239]
    ds_read_b64_tr_b16 a[136:137], v8 offset:49152
    v_mfma_f32_16x16x32_bf16 v[240:243], a[104:107], a[4:7], v[240:243]
    ds_read_b64_tr_b16 a[138:139], v8 offset:49664
    v_mfma_f32_16x16x32_bf16 v[244:247], a[108:111], a[0:3], v[244:247]
    ds_read_b64_tr_b16 a[140:141], v9 offset:49152
    v_mfma_f32_16x16x32_bf16 v[248:251], a[108:111], a[4:7], v[248:251]
    ds_read_b64_tr_b16 a[142:143], v9 offset:49664
    buffer_load_dwordx4 v194, s[20:23], s74 offen offset:2048 lds
    s_waitcnt lgkmcnt(8)
    v_mfma_f32_16x16x32_bf16 v[220:223], a[112:115], a[8:11], v[220:223]
    ds_read_b64_tr_b16 a[144:145], v6 offset:53248
    v_mfma_f32_16x16x32_bf16 v[224:227], a[112:115], a[12:15], v[224:227]
    ds_read_b64_tr_b16 a[146:147], v6 offset:53760
    buffer_load_dwordx4 a[72:75], v1, s[28:31], s75 offen offset:2048 sc1
    v_mfma_f32_16x16x32_bf16 v[228:231], a[116:119], a[8:11], v[228:231]
    ds_read_b64_tr_b16 a[148:149], v7 offset:53248
    v_mfma_f32_16x16x32_bf16 v[232:235], a[116:119], a[12:15], v[232:235]
    ds_read_b64_tr_b16 a[150:151], v7 offset:53760
    v_mfma_f32_16x16x32_bf16 v[236:239], a[120:123], a[8:11], v[236:239]
    ds_read_b64_tr_b16 a[152:153], v8 offset:53248
    v_mfma_f32_16x16x32_bf16 v[240:243], a[120:123], a[12:15], v[240:243]
    ds_read_b64_tr_b16 a[154:155], v8 offset:53760
    buffer_load_dwordx4 v195, s[20:23], s74 offen offset:3072 lds
    v_mfma_f32_16x16x32_bf16 v[244:247], a[124:127], a[8:11], v[244:247]
    ds_read_b64_tr_b16 a[156:157], v9 offset:53248
    v_mfma_f32_16x16x32_bf16 v[248:251], a[124:127], a[12:15], v[248:251]
    ds_read_b64_tr_b16 a[158:159], v9 offset:53760
    s_waitcnt vmcnt(16)
    s_barrier
    s_waitcnt lgkmcnt(8)
    v_mfma_f32_16x16x32_bf16 v[220:223], a[128:131], a[16:19], v[220:223]
    ds_read_b64_tr_b16 a[96:97], v204 offset:0
    v_mfma_f32_16x16x32_bf16 v[224:227], a[128:131], a[20:23], v[224:227]
    ds_read_b64_tr_b16 a[98:99], v204 offset:512
    buffer_load_dwordx4 a[76:79], v1, s[28:31], s75 offen offset:3072 sc1
    v_mfma_f32_16x16x32_bf16 v[228:231], a[132:135], a[16:19], v[228:231]
    ds_read_b64_tr_b16 a[100:101], v205 offset:0
    v_mfma_f32_16x16x32_bf16 v[232:235], a[132:135], a[20:23], v[232:235]
    ds_read_b64_tr_b16 a[102:103], v205 offset:512
    s_bfe_u32 s76, s53, 0x4000c
    s_mul_i32 s74, s76, 458752
    s_add_u32 m0, s78, 49152
    s_add_u32 s74, s74, s58
    buffer_load_dwordx4 v192, s[20:23], s74 offen lds
    v_mfma_f32_16x16x32_bf16 v[236:239], a[136:139], a[16:19], v[236:239]
    ds_read_b64_tr_b16 a[104:105], v206 offset:0
    v_mfma_f32_16x16x32_bf16 v[240:243], a[136:139], a[20:23], v[240:243]
    ds_read_b64_tr_b16 a[106:107], v206 offset:512
    v_mfma_f32_16x16x32_bf16 v[244:247], a[140:143], a[16:19], v[244:247]
    ds_read_b64_tr_b16 a[108:109], v207 offset:0
    v_mfma_f32_16x16x32_bf16 v[248:251], a[140:143], a[20:23], v[248:251]
    ds_read_b64_tr_b16 a[110:111], v207 offset:512
    s_bfe_u32 s76, s53, 0x4000c
    s_lshl_b32 s75, s76, 13
    s_add_u32 s75, s75, s61
    buffer_load_dwordx4 a[80:83], v1, s[28:31], s75 offen offset:0 sc1
    s_waitcnt lgkmcnt(8)
    v_mfma_f32_16x16x32_bf16 v[220:223], a[144:147], a[24:27], v[220:223]
    ds_read_b64_tr_b16 a[112:113], v204 offset:4096
    v_mfma_f32_16x16x32_bf16 v[224:227], a[144:147], a[28:31], v[224:227]
    ds_read_b64_tr_b16 a[114:115], v204 offset:4608
    buffer_load_dwordx4 v193, s[20:23], s74 offen offset:1024 lds
    v_mfma_f32_16x16x32_bf16 v[228:231], a[148:151], a[24:27], v[228:231]
    ds_read_b64_tr_b16 a[116:117], v205 offset:4096
    v_mfma_f32_16x16x32_bf16 v[232:235], a[148:151], a[28:31], v[232:235]
    ds_read_b64_tr_b16 a[118:119], v205 offset:4608
    v_mfma_f32_16x16x32_bf16 v[236:239], a[152:155], a[24:27], v[236:239]
    ds_read_b64_tr_b16 a[120:121], v206 offset:4096
    v_mfma_f32_16x16x32_bf16 v[240:243], a[152:155], a[28:31], v[240:243]
    ds_read_b64_tr_b16 a[122:123], v206 offset:4608
    buffer_load_dwordx4 a[84:87], v1, s[28:31], s75 offen offset:1024 sc1
    v_mfma_f32_16x16x32_bf16 v[244:247], a[156:159], a[24:27], v[244:247]
    ds_read_b64_tr_b16 a[124:125], v207 offset:4096
    v_mfma_f32_16x16x32_bf16 v[248:251], a[156:159], a[28:31], v[248:251]
    ds_read_b64_tr_b16 a[126:127], v207 offset:4608
    s_waitcnt vmcnt(13)
    s_barrier
    s_waitcnt lgkmcnt(8)
    v_mfma_f32_16x16x32_bf16 v[220:223], a[96:99], a[32:35], v[220:223]
    ds_read_b64_tr_b16 a[128:129], v204 offset:16384
    v_mfma_f32_16x16x32_bf16 v[224:227], a[96:99], a[36:39], v[224:227]
    ds_read_b64_tr_b16 a[130:131], v204 offset:16896
    buffer_load_dwordx4 v194, s[20:23], s74 offen offset:2048 lds
    v_mfma_f32_16x16x32_bf16 v[228:231], a[100:103], a[32:35], v[228:231]
    ds_read_b64_tr_b16 a[132:133], v205 offset:16384
    v_mfma_f32_16x16x32_bf16 v[232:235], a[100:103], a[36:39], v[232:235]
    ds_read_b64_tr_b16 a[134:135], v205 offset:16896
    buffer_load_dwordx4 a[88:91], v1, s[28:31], s75 offen offset:2048 sc1
    v_mfma_f32_16x16x32_bf16 v[236:239], a[104:107], a[32:35], v[236:239]
    ds_read_b64_tr_b16 a[136:137], v206 offset:16384
    v_mfma_f32_16x16x32_bf16 v[240:243], a[104:107], a[36:39], v[240:243]
    ds_read_b64_tr_b16 a[138:139], v206 offset:16896
    v_mfma_f32_16x16x32_bf16 v[244:247], a[108:111], a[32:35], v[244:247]
    ds_read_b64_tr_b16 a[140:141], v207 offset:16384
    v_mfma_f32_16x16x32_bf16 v[248:251], a[108:111], a[36:39], v[248:251]
    ds_read_b64_tr_b16 a[142:143], v207 offset:16896
    buffer_load_dwordx4 v195, s[20:23], s74 offen offset:3072 lds
    s_waitcnt lgkmcnt(8)
    v_mfma_f32_16x16x32_bf16 v[220:223], a[112:115], a[40:43], v[220:223]
    ds_read_b64_tr_b16 a[144:145], v204 offset:20480
    v_mfma_f32_16x16x32_bf16 v[224:227], a[112:115], a[44:47], v[224:227]
    ds_read_b64_tr_b16 a[146:147], v204 offset:20992
    buffer_load_dwordx4 a[92:95], v1, s[28:31], s75 offen offset:3072 sc1
    v_mfma_f32_16x16x32_bf16 v[228:231], a[116:119], a[40:43], v[228:231]
    ds_read_b64_tr_b16 a[148:149], v205 offset:20480
    v_mfma_f32_16x16x32_bf16 v[232:235], a[116:119], a[44:47], v[232:235]
    ds_read_b64_tr_b16 a[150:151], v205 offset:20992
    v_mfma_f32_16x16x32_bf16 v[236:239], a[120:123], a[40:43], v[236:239]
    ds_read_b64_tr_b16 a[152:153], v206 offset:20480
    v_mfma_f32_16x16x32_bf16 v[240:243], a[120:123], a[44:47], v[240:243]
    ds_read_b64_tr_b16 a[154:155], v206 offset:20992
    s_bfe_u32 s76, s53, 0x40010
    s_mul_i32 s74, s76, 458752
    s_add_u32 m0, s78, 65536
    s_add_u32 s74, s74, s58
    buffer_load_dwordx4 v192, s[20:23], s74 offen lds
    v_mfma_f32_16x16x32_bf16 v[244:247], a[124:127], a[40:43], v[244:247]
    ds_read_b64_tr_b16 a[156:157], v207 offset:20480
    v_mfma_f32_16x16x32_bf16 v[248:251], a[124:127], a[44:47], v[248:251]
    ds_read_b64_tr_b16 a[158:159], v207 offset:20992
    s_waitcnt vmcnt(10)
    s_barrier
    s_waitcnt lgkmcnt(8)
    v_mfma_f32_16x16x32_bf16 v[220:223], a[128:131], a[48:51], v[220:223]
    ds_read_b64_tr_b16 a[96:97], v204 offset:32768
    v_mfma_f32_16x16x32_bf16 v[224:227], a[128:131], a[52:55], v[224:227]
    ds_read_b64_tr_b16 a[98:99], v204 offset:33280
    s_bfe_u32 s76, s53, 0x40010
    s_lshl_b32 s75, s76, 13
    s_add_u32 s75, s75, s61
    buffer_load_dwordx4 a[0:3], v1, s[28:31], s75 offen offset:0 sc1
    v_mfma_f32_16x16x32_bf16 v[228:231], a[132:135], a[48:51], v[228:231]
    ds_read_b64_tr_b16 a[100:101], v205 offset:32768
    v_mfma_f32_16x16x32_bf16 v[232:235], a[132:135], a[52:55], v[232:235]
    ds_read_b64_tr_b16 a[102:103], v205 offset:33280
    buffer_load_dwordx4 v193, s[20:23], s74 offen offset:1024 lds
    v_mfma_f32_16x16x32_bf16 v[236:239], a[136:139], a[48:51], v[236:239]
    ds_read_b64_tr_b16 a[104:105], v206 offset:32768
    v_mfma_f32_16x16x32_bf16 v[240:243], a[136:139], a[52:55], v[240:243]
    ds_read_b64_tr_b16 a[106:107], v206 offset:33280
    v_mfma_f32_16x16x32_bf16 v[244:247], a[140:143], a[48:51], v[244:247]
    ds_read_b64_tr_b16 a[108:109], v207 offset:32768
    v_mfma_f32_16x16x32_bf16 v[248:251], a[140:143], a[52:55], v[248:251]
    ds_read_b64_tr_b16 a[110:111], v207 offset:33280
    buffer_load_dwordx4 a[4:7], v1, s[28:31], s75 offen offset:1024 sc1
    s_waitcnt lgkmcnt(8)
    v_mfma_f32_16x16x32_bf16 v[220:223], a[144:147], a[56:59], v[220:223]
    ds_read_b64_tr_b16 a[112:113], v204 offset:36864
    v_mfma_f32_16x16x32_bf16 v[224:227], a[144:147], a[60:63], v[224:227]
    ds_read_b64_tr_b16 a[114:115], v204 offset:37376
    buffer_load_dwordx4 v194, s[20:23], s74 offen offset:2048 lds
    v_mfma_f32_16x16x32_bf16 v[228:231], a[148:151], a[56:59], v[228:231]
    ds_read_b64_tr_b16 a[116:117], v205 offset:36864
    v_mfma_f32_16x16x32_bf16 v[232:235], a[148:151], a[60:63], v[232:235]
    ds_read_b64_tr_b16 a[118:119], v205 offset:37376
    v_mfma_f32_16x16x32_bf16 v[236:239], a[152:155], a[56:59], v[236:239]
    ds_read_b64_tr_b16 a[120:121], v206 offset:36864
    v_mfma_f32_16x16x32_bf16 v[240:243], a[152:155], a[60:63], v[240:243]
    ds_read_b64_tr_b16 a[122:123], v206 offset:37376
    buffer_load_dwordx4 a[8:11], v1, s[28:31], s75 offen offset:2048 sc1
    v_mfma_f32_16x16x32_bf16 v[244:247], a[156:159], a[56:59], v[244:247]
    ds_read_b64_tr_b16 a[124:125], v207 offset:36864
    v_mfma_f32_16x16x32_bf16 v[248:251], a[156:159], a[60:63], v[248:251]
    ds_read_b64_tr_b16 a[126:127], v207 offset:37376
    buffer_load_dwordx4 v195, s[20:23], s74 offen offset:3072 lds
    buffer_load_dwordx4 a[12:15], v1, s[28:31], s75 offen offset:3072 sc1
    s_bfe_u32 s76, s53, 0x40014
    s_mul_i32 s74, s76, 458752
    s_add_u32 m0, s78, 81920
    s_add_u32 s74, s74, s58
    buffer_load_dwordx4 v192, s[20:23], s74 offen lds
    s_waitcnt vmcnt(10)
    s_barrier
    s_waitcnt lgkmcnt(8)
    v_mfma_f32_16x16x32_bf16 v[220:223], a[96:99], a[64:67], v[220:223]
    ds_read_b64_tr_b16 a[128:129], v204 offset:49152
    v_mfma_f32_16x16x32_bf16 v[224:227], a[96:99], a[68:71], v[224:227]
    ds_read_b64_tr_b16 a[130:131], v204 offset:49664
    s_bfe_u32 s76, s53, 0x40014
    s_lshl_b32 s75, s76, 13
    s_add_u32 s75, s75, s61
    buffer_load_dwordx4 a[16:19], v1, s[28:31], s75 offen offset:0 sc1
    v_mfma_f32_16x16x32_bf16 v[228:231], a[100:103], a[64:67], v[228:231]
    ds_read_b64_tr_b16 a[132:133], v205 offset:49152
    v_mfma_f32_16x16x32_bf16 v[232:235], a[100:103], a[68:71], v[232:235]
    ds_read_b64_tr_b16 a[134:135], v205 offset:49664
    buffer_load_dwordx4 v193, s[20:23], s74 offen offset:1024 lds
    v_mfma_f32_16x16x32_bf16 v[236:239], a[104:107], a[64:67], v[236:239]
    ds_read_b64_tr_b16 a[136:137], v206 offset:49152
    v_mfma_f32_16x16x32_bf16 v[240:243], a[104:107], a[68:71], v[240:243]
    ds_read_b64_tr_b16 a[138:139], v206 offset:49664
    v_mfma_f32_16x16x32_bf16 v[244:247], a[108:111], a[64:67], v[244:247]
    ds_read_b64_tr_b16 a[140:141], v207 offset:49152
    v_mfma_f32_16x16x32_bf16 v[248:251], a[108:111], a[68:71], v[248:251]
    ds_read_b64_tr_b16 a[142:143], v207 offset:49664
    buffer_load_dwordx4 a[20:23], v1, s[28:31], s75 offen offset:1024 sc1
    s_waitcnt lgkmcnt(8)
    v_mfma_f32_16x16x32_bf16 v[220:223], a[112:115], a[72:75], v[220:223]
    ds_read_b64_tr_b16 a[144:145], v204 offset:53248
    v_mfma_f32_16x16x32_bf16 v[224:227], a[112:115], a[76:79], v[224:227]
    ds_read_b64_tr_b16 a[146:147], v204 offset:53760
    buffer_load_dwordx4 v194, s[20:23], s74 offen offset:2048 lds
    v_mfma_f32_16x16x32_bf16 v[228:231], a[116:119], a[72:75], v[228:231]
    ds_read_b64_tr_b16 a[148:149], v205 offset:53248
    v_mfma_f32_16x16x32_bf16 v[232:235], a[116:119], a[76:79], v[232:235]
    ds_read_b64_tr_b16 a[150:151], v205 offset:53760
    v_mfma_f32_16x16x32_bf16 v[236:239], a[120:123], a[72:75], v[236:239]
    ds_read_b64_tr_b16 a[152:153], v206 offset:53248
    v_mfma_f32_16x16x32_bf16 v[240:243], a[120:123], a[76:79], v[240:243]
    ds_read_b64_tr_b16 a[154:155], v206 offset:53760
    buffer_load_dwordx4 a[24:27], v1, s[28:31], s75 offen offset:2048 sc1
    v_mfma_f32_16x16x32_bf16 v[244:247], a[124:127], a[72:75], v[244:247]
    ds_read_b64_tr_b16 a[156:157], v207 offset:53248
    v_mfma_f32_16x16x32_bf16 v[248:251], a[124:127], a[76:79], v[248:251]
    ds_read_b64_tr_b16 a[158:159], v207 offset:53760
    buffer_load_dwordx4 v195, s[20:23], s74 offen offset:3072 lds
    buffer_load_dwordx4 a[28:31], v1, s[28:31], s75 offen offset:3072 sc1
    s_bfe_u32 s76, s53, 0x40018
    s_mul_i32 s74, s76, 458752
    s_add_u32 m0, s78, 98304
    s_add_u32 s74, s74, s58
    buffer_load_dwordx4 v192, s[20:23], s74 offen lds
    s_waitcnt vmcnt(10)
    s_barrier
    s_waitcnt lgkmcnt(8)
    v_mfma_f32_16x16x32_bf16 v[220:223], a[128:131], a[80:83], v[220:223]
    ds_read_b64_tr_b16 a[96:97], v6 offset:0
    v_mfma_f32_16x16x32_bf16 v[224:227], a[128:131], a[84:87], v[224:227]
    ds_read_b64_tr_b16 a[98:99], v6 offset:512
    buffer_load_dwordx4 v193, s[20:23], s74 offen offset:1024 lds
    v_mfma_f32_16x16x32_bf16 v[228:231], a[132:135], a[80:83], v[228:231]
    ds_read_b64_tr_b16 a[100:101], v7 offset:0
    v_mfma_f32_16x16x32_bf16 v[232:235], a[132:135], a[84:87], v[232:235]
    ds_read_b64_tr_b16 a[102:103], v7 offset:512
    buffer_load_dwordx4 v194, s[20:23], s74 offen offset:2048 lds
    v_mfma_f32_16x16x32_bf16 v[236:239], a[136:139], a[80:83], v[236:239]
    ds_read_b64_tr_b16 a[104:105], v8 offset:0
    v_mfma_f32_16x16x32_bf16 v[240:243], a[136:139], a[84:87], v[240:243]
    ds_read_b64_tr_b16 a[106:107], v8 offset:512
    v_mfma_f32_16x16x32_bf16 v[244:247], a[140:143], a[80:83], v[244:247]
    ds_read_b64_tr_b16 a[108:109], v9 offset:0
    v_mfma_f32_16x16x32_bf16 v[248:251], a[140:143], a[84:87], v[248:251]
    ds_read_b64_tr_b16 a[110:111], v9 offset:512
    buffer_load_dwordx4 v195, s[20:23], s74 offen offset:3072 lds
    s_waitcnt lgkmcnt(8)
    v_mfma_f32_16x16x32_bf16 v[220:223], a[144:147], a[88:91], v[220:223]
    ds_read_b64_tr_b16 a[112:113], v6 offset:4096
    v_mfma_f32_16x16x32_bf16 v[224:227], a[144:147], a[92:95], v[224:227]
    ds_read_b64_tr_b16 a[114:115], v6 offset:4608
    s_bfe_u32 s76, s53, 0x4001c
    s_mul_i32 s74, s76, 458752
    s_add_u32 m0, s78, 114688
    s_add_u32 s74, s74, s58
    buffer_load_dwordx4 v192, s[20:23], s74 offen lds
    v_mfma_f32_16x16x32_bf16 v[228:231], a[148:151], a[88:91], v[228:231]
    ds_read_b64_tr_b16 a[116:117], v7 offset:4096
    v_mfma_f32_16x16x32_bf16 v[232:235], a[148:151], a[92:95], v[232:235]
    ds_read_b64_tr_b16 a[118:119], v7 offset:4608
    v_mfma_f32_16x16x32_bf16 v[236:239], a[152:155], a[88:91], v[236:239]
    ds_read_b64_tr_b16 a[120:121], v8 offset:4096
    v_mfma_f32_16x16x32_bf16 v[240:243], a[152:155], a[92:95], v[240:243]
    ds_read_b64_tr_b16 a[122:123], v8 offset:4608
    buffer_load_dwordx4 v193, s[20:23], s74 offen offset:1024 lds
    v_mfma_f32_16x16x32_bf16 v[244:247], a[156:159], a[88:91], v[244:247]
    ds_read_b64_tr_b16 a[124:125], v9 offset:4096
    v_mfma_f32_16x16x32_bf16 v[248:251], a[156:159], a[92:95], v[248:251]
    ds_read_b64_tr_b16 a[126:127], v9 offset:4608
    buffer_load_dwordx4 v194, s[20:23], s74 offen offset:2048 lds
    buffer_load_dwordx4 v195, s[20:23], s74 offen offset:3072 lds
    s_bfe_u32 s76, s53, 0x40018
    s_lshl_b32 s75, s76, 13
    s_add_u32 s75, s75, s61
    buffer_load_dwordx4 a[32:35], v1, s[28:31], s75 offen offset:0 sc1
    s_waitcnt vmcnt(10)
    s_barrier
    s_waitcnt lgkmcnt(8)
    v_mfma_f32_16x16x32_bf16 v[220:223], a[96:99], a[0:3], v[220:223]
    ds_read_b64_tr_b16 a[128:129], v6 offset:16384
    v_mfma_f32_16x16x32_bf16 v[224:227], a[96:99], a[4:7], v[224:227]
    ds_read_b64_tr_b16 a[130:131], v6 offset:16896
    buffer_load_dwordx4 a[36:39], v1, s[28:31], s75 offen offset:1024 sc1
    v_mfma_f32_16x16x32_bf16 v[228:231], a[100:103], a[0:3], v[228:231]
    ds_read_b64_tr_b16 a[132:133], v7 offset:16384
    v_mfma_f32_16x16x32_bf16 v[232:235], a[100:103], a[4:7], v[232:235]
    ds_read_b64_tr_b16 a[134:135], v7 offset:16896
    buffer_load_dwordx4 a[40:43], v1, s[28:31], s75 offen offset:2048 sc1
    v_mfma_f32_16x16x32_bf16 v[236:239], a[104:107], a[0:3], v[236:239]
    ds_read_b64_tr_b16 a[136:137], v8 offset:16384
    v_mfma_f32_16x16x32_bf16 v[240:243], a[104:107], a[4:7], v[240:243]
    ds_read_b64_tr_b16 a[138:139], v8 offset:16896
    v_mfma_f32_16x16x32_bf16 v[244:247], a[108:111], a[0:3], v[244:247]
    ds_read_b64_tr_b16 a[140:141], v9 offset:16384
    v_mfma_f32_16x16x32_bf16 v[248:251], a[108:111], a[4:7], v[248:251]
    ds_read_b64_tr_b16 a[142:143], v9 offset:16896
    buffer_load_dwordx4 a[44:47], v1, s[28:31], s75 offen offset:3072 sc1
    s_waitcnt lgkmcnt(8)
    v_mfma_f32_16x16x32_bf16 v[220:223], a[112:115], a[8:11], v[220:223]
    ds_read_b64_tr_b16 a[144:145], v6 offset:20480
    v_mfma_f32_16x16x32_bf16 v[224:227], a[112:115], a[12:15], v[224:227]
    ds_read_b64_tr_b16 a[146:147], v6 offset:20992
    s_bfe_u32 s76, s53, 0x4001c
    s_lshl_b32 s75, s76, 13
    s_add_u32 s75, s75, s61
    buffer_load_dwordx4 a[48:51], v1, s[28:31], s75 offen offset:0 sc1
    v_mfma_f32_16x16x32_bf16 v[228:231], a[116:119], a[8:11], v[228:231]
    ds_read_b64_tr_b16 a[148:149], v7 offset:20480
    v_mfma_f32_16x16x32_bf16 v[232:235], a[116:119], a[12:15], v[232:235]
    ds_read_b64_tr_b16 a[150:151], v7 offset:20992
    v_mfma_f32_16x16x32_bf16 v[236:239], a[120:123], a[8:11], v[236:239]
    ds_read_b64_tr_b16 a[152:153], v8 offset:20480
    v_mfma_f32_16x16x32_bf16 v[240:243], a[120:123], a[12:15], v[240:243]
    ds_read_b64_tr_b16 a[154:155], v8 offset:20992
    buffer_load_dwordx4 a[52:55], v1, s[28:31], s75 offen offset:1024 sc1
    v_mfma_f32_16x16x32_bf16 v[244:247], a[124:127], a[8:11], v[244:247]
    ds_read_b64_tr_b16 a[156:157], v9 offset:20480
    v_mfma_f32_16x16x32_bf16 v[248:251], a[124:127], a[12:15], v[248:251]
    ds_read_b64_tr_b16 a[158:159], v9 offset:20992
    s_waitcnt vmcnt(10)
    s_barrier
    s_waitcnt lgkmcnt(8)
    v_mfma_f32_16x16x32_bf16 v[220:223], a[128:131], a[16:19], v[220:223]
    ds_read_b64_tr_b16 a[96:97], v6 offset:32768
    v_mfma_f32_16x16x32_bf16 v[224:227], a[128:131], a[20:23], v[224:227]
    ds_read_b64_tr_b16 a[98:99], v6 offset:33280
    buffer_load_dwordx4 a[56:59], v1, s[28:31], s75 offen offset:2048 sc1
    v_mfma_f32_16x16x32_bf16 v[228:231], a[132:135], a[16:19], v[228:231]
    ds_read_b64_tr_b16 a[100:101], v7 offset:32768
    v_mfma_f32_16x16x32_bf16 v[232:235], a[132:135], a[20:23], v[232:235]
    ds_read_b64_tr_b16 a[102:103], v7 offset:33280
    buffer_load_dwordx4 a[60:63], v1, s[28:31], s75 offen offset:3072 sc1
    v_mfma_f32_16x16x32_bf16 v[236:239], a[136:139], a[16:19], v[236:239]
    ds_read_b64_tr_b16 a[104:105], v8 offset:32768
    v_mfma_f32_16x16x32_bf16 v[240:243], a[136:139], a[20:23], v[240:243]
    ds_read_b64_tr_b16 a[106:107], v8 offset:33280
    v_mfma_f32_16x16x32_bf16 v[244:247], a[140:143], a[16:19], v[244:247]
    ds_read_b64_tr_b16 a[108:109], v9 offset:32768
    v_mfma_f32_16x16x32_bf16 v[248:251], a[140:143], a[20:23], v[248:251]
    ds_read_b64_tr_b16 a[110:111], v9 offset:33280
    s_waitcnt lgkmcnt(8)
    v_mfma_f32_16x16x32_bf16 v[220:223], a[144:147], a[24:27], v[220:223]
    ds_read_b64_tr_b16 a[112:113], v6 offset:36864
    v_mfma_f32_16x16x32_bf16 v[224:227], a[144:147], a[28:31], v[224:227]
    ds_read_b64_tr_b16 a[114:115], v6 offset:37376
    v_mfma_f32_16x16x32_bf16 v[228:231], a[148:151], a[24:27], v[228:231]
    ds_read_b64_tr_b16 a[116:117], v7 offset:36864
    v_mfma_f32_16x16x32_bf16 v[232:235], a[148:151], a[28:31], v[232:235]
    ds_read_b64_tr_b16 a[118:119], v7 offset:37376
    v_mfma_f32_16x16x32_bf16 v[236:239], a[152:155], a[24:27], v[236:239]
    ds_read_b64_tr_b16 a[120:121], v8 offset:36864
    v_mfma_f32_16x16x32_bf16 v[240:243], a[152:155], a[28:31], v[240:243]
    ds_read_b64_tr_b16 a[122:123], v8 offset:37376
    v_mfma_f32_16x16x32_bf16 v[244:247], a[156:159], a[24:27], v[244:247]
    ds_read_b64_tr_b16 a[124:125], v9 offset:36864
    v_mfma_f32_16x16x32_bf16 v[248:251], a[156:159], a[28:31], v[248:251]
    ds_read_b64_tr_b16 a[126:127], v9 offset:37376
    s_waitcnt vmcnt(8)
    s_barrier
    s_waitcnt vmcnt(6)
    s_waitcnt lgkmcnt(8)
    v_mfma_f32_16x16x32_bf16 v[220:223], a[96:99], a[32:35], v[220:223]
    ds_read_b64_tr_b16 a[128:129], v6 offset:49152
    v_mfma_f32_16x16x32_bf16 v[224:227], a[96:99], a[36:39], v[224:227]
    ds_read_b64_tr_b16 a[130:131], v6 offset:49664
    s_bfe_u32 s76, s56, 0x40000
    s_mul_i32 s74, s76, 524288
    s_add_u32 m0, s78, 0
    s_add_u32 s74, s74, s60
    buffer_load_dwordx4 v200, s[24:27], s74 offen lds
    v_mfma_f32_16x16x32_bf16 v[228:231], a[100:103], a[32:35], v[228:231]
    ds_read_b64_tr_b16 a[132:133], v7 offset:49152
    v_mfma_f32_16x16x32_bf16 v[232:235], a[100:103], a[36:39], v[232:235]
    ds_read_b64_tr_b16 a[134:135], v7 offset:49664
    buffer_load_dwordx4 v201, s[24:27], s74 offen offset:1024 lds
    v_mfma_f32_16x16x32_bf16 v[236:239], a[104:107], a[32:35], v[236:239]
    ds_read_b64_tr_b16 a[136:137], v8 offset:49152
    v_mfma_f32_16x16x32_bf16 v[240:243], a[104:107], a[36:39], v[240:243]
    ds_read_b64_tr_b16 a[138:139], v8 offset:49664
    v_mfma_f32_16x16x32_bf16 v[244:247], a[108:111], a[32:35], v[244:247]
    ds_read_b64_tr_b16 a[140:141], v9 offset:49152
    v_mfma_f32_16x16x32_bf16 v[248:251], a[108:111], a[36:39], v[248:251]
    ds_read_b64_tr_b16 a[142:143], v9 offset:49664
    s_waitcnt vmcnt(6)
    s_waitcnt lgkmcnt(8)
    v_mfma_f32_16x16x32_bf16 v[220:223], a[112:115], a[40:43], v[220:223]
    ds_read_b64_tr_b16 a[144:145], v6 offset:53248
    v_mfma_f32_16x16x32_bf16 v[224:227], a[112:115], a[44:47], v[224:227]
    ds_read_b64_tr_b16 a[146:147], v6 offset:53760
    buffer_load_dwordx4 v202, s[24:27], s74 offen offset:2048 lds
    v_mfma_f32_16x16x32_bf16 v[228:231], a[116:119], a[40:43], v[228:231]
    ds_read_b64_tr_b16 a[148:149], v7 offset:53248
    v_mfma_f32_16x16x32_bf16 v[232:235], a[116:119], a[44:47], v[232:235]
    ds_read_b64_tr_b16 a[150:151], v7 offset:53760
    buffer_load_dwordx4 v203, s[24:27], s74 offen offset:3072 lds
    v_mfma_f32_16x16x32_bf16 v[236:239], a[120:123], a[40:43], v[236:239]
    ds_read_b64_tr_b16 a[152:153], v8 offset:53248
    v_mfma_f32_16x16x32_bf16 v[240:243], a[120:123], a[44:47], v[240:243]
    ds_read_b64_tr_b16 a[154:155], v8 offset:53760
    v_mfma_f32_16x16x32_bf16 v[244:247], a[124:127], a[40:43], v[244:247]
    ds_read_b64_tr_b16 a[156:157], v9 offset:53248
    v_mfma_f32_16x16x32_bf16 v[248:251], a[124:127], a[44:47], v[248:251]
    ds_read_b64_tr_b16 a[158:159], v9 offset:53760
    v_xor_b32 v217, 4096, v216
    s_waitcnt vmcnt(6)
    s_waitcnt lgkmcnt(10)
    v_mfma_f32_16x16x32_bf16 v[236:239], a[136:139], a[48:51], v[236:239]
    v_mfma_f32_16x16x32_bf16 v[240:243], a[136:139], a[52:55], v[240:243]
    s_waitcnt lgkmcnt(8)
    v_mfma_f32_16x16x32_bf16 v[244:247], a[140:143], a[48:51], v[244:247]
    v_mfma_f32_16x16x32_bf16 v[248:251], a[140:143], a[52:55], v[248:251]
    s_waitcnt vmcnt(4)
    s_waitcnt lgkmcnt(2)
    v_mfma_f32_16x16x32_bf16 v[236:239], a[152:155], a[56:59], v[236:239]
    v_mfma_f32_16x16x32_bf16 v[240:243], a[152:155], a[60:63], v[240:243]
    s_waitcnt lgkmcnt(0)
    v_mfma_f32_16x16x32_bf16 v[244:247], a[156:159], a[56:59], v[244:247]
    v_mfma_f32_16x16x32_bf16 v[248:251], a[156:159], a[60:63], v[248:251]
    v_mfma_f32_16x16x32_bf16 v[220:223], a[128:131], a[48:51], v[220:223]
    v_mfma_f32_16x16x32_bf16 v[224:227], a[128:131], a[52:55], v[224:227]
    v_mfma_f32_16x16x32_bf16 v[228:231], a[132:135], a[48:51], v[228:231]
    v_mfma_f32_16x16x32_bf16 v[232:235], a[132:135], a[52:55], v[232:235]
    ds_write_b128 v216, v[236:239] offset:0
    v_mfma_f32_16x16x32_bf16 v[220:223], a[144:147], a[56:59], v[220:223]
    v_mfma_f32_16x16x32_bf16 v[224:227], a[144:147], a[60:63], v[224:227]
    ds_write_b128 v216, v[240:243] offset:1024
    ds_write_b128 v216, v[244:247] offset:2048
    v_mfma_f32_16x16x32_bf16 v[228:231], a[148:151], a[56:59], v[228:231]
    v_mfma_f32_16x16x32_bf16 v[232:235], a[148:151], a[60:63], v[232:235]
    ds_write_b128 v216, v[248:251] offset:3072
    s_bfe_u32 s76, s56, 0x40004
    s_mul_i32 s74, s76, 524288
    s_add_u32 m0, s78, 16384
    s_add_u32 s74, s74, s60
    buffer_load_dwordx4 v200, s[24:27], s74 offen lds
    buffer_load_dwordx4 v201, s[24:27], s74 offen offset:1024 lds
    s_mov_b32 s4, 0xbdd2d3e8
    s_mov_b32 s5, 0xc0135761
    s_mul_i32 s6, s80, 112
    s_lshl_b32 s7, s68, 2
    s_add_u32 s6, s6, s7
    s_lshl_b32 s7, s46, 1
    s_add_u32 s6, s6, s7
    s_lshl_b32 s6, s6, 10
    s_add_u32 s6, s6, 2097152
    s_waitcnt lgkmcnt(0)
    s_barrier
    ds_read_b128 v[236:239], v217 offset:0
    ds_read_b128 v[240:243], v217 offset:1024
    ds_read_b128 v[244:247], v217 offset:2048
    ds_read_b128 v[248:251], v217 offset:3072
    buffer_load_dwordx4 v202, s[24:27], s74 offen offset:2048 lds
    buffer_load_dwordx4 v203, s[24:27], s74 offen offset:3072 lds
    s_bfe_u32 s76, s56, 0x40008
    s_mul_i32 s74, s76, 524288
    s_add_u32 m0, s78, 32768
    s_add_u32 s74, s74, s60
    buffer_load_dwordx4 v200, s[24:27], s74 offen lds
    buffer_load_dwordx4 v201, s[24:27], s74 offen offset:1024 lds
    s_waitcnt lgkmcnt(3)
    v_pk_add_f32 v[220:221], v[220:221], v[236:237]
    v_pk_add_f32 v[222:223], v[222:223], v[238:239]
    s_waitcnt lgkmcnt(2)
    v_pk_add_f32 v[224:225], v[224:225], v[240:241]
    v_pk_add_f32 v[226:227], v[226:227], v[242:243]
    s_waitcnt lgkmcnt(1)
    v_pk_add_f32 v[228:229], v[228:229], v[244:245]
    v_pk_add_f32 v[230:231], v[230:231], v[246:247]
    s_waitcnt lgkmcnt(0)
    v_pk_add_f32 v[232:233], v[232:233], v[248:249]
    v_pk_add_f32 v[234:235], v[234:235], v[250:251]
    v_pk_mul_f32 v[96:97], v[220:221], v[220:221]
    v_pk_mul_f32 v[98:99], v[222:223], v[222:223]
    v_pk_mul_f32 v[104:105], v[228:229], v[228:229]
    v_pk_mul_f32 v[106:107], v[230:231], v[230:231]
    v_pk_fma_f32 v[96:97], v[96:97], s[4:5], s[4:5] op_sel:[0,0,1] op_sel_hi:[1,0,1]
    v_pk_fma_f32 v[98:99], v[98:99], s[4:5], s[4:5] op_sel:[0,0,1] op_sel_hi:[1,0,1]
    v_pk_fma_f32 v[104:105], v[104:105], s[4:5], s[4:5] op_sel:[0,0,1] op_sel_hi:[1,0,1]
    v_pk_fma_f32 v[106:107], v[106:107], s[4:5], s[4:5] op_sel:[0,0,1] op_sel_hi:[1,0,1]
    v_pk_mul_f32 v[96:97], v[96:97], v[220:221]
    v_pk_mul_f32 v[98:99], v[98:99], v[222:223]
    v_pk_mul_f32 v[104:105], v[104:105], v[228:229]
    v_pk_mul_f32 v[106:107], v[106:107], v[230:231]
    v_exp_f32 v96, v96
    v_exp_f32 v97, v97
    v_exp_f32 v98, v98
    v_exp_f32 v99, v99
    v_exp_f32 v104, v104
    v_exp_f32 v105, v105
    v_exp_f32 v106, v106
    v_exp_f32 v107, v107
    v_pk_add_f32 v[96:97], v[96:97], 1.0 op_sel_hi:[1,0]
    v_pk_add_f32 v[98:99], v[98:99], 1.0 op_sel_hi:[1,0]
    v_pk_add_f32 v[104:105], v[104:105], 1.0 op_sel_hi:[1,0]
    v_pk_add_f32 v[106:107], v[106:107], 1.0 op_sel_hi:[1,0]
    v_rcp_f32 v96, v96
    v_rcp_f32 v97, v97
    v_rcp_f32 v98, v98
    v_rcp_f32 v99, v99
    v_rcp_f32 v104, v104
    v_rcp_f32 v105, v105
    v_rcp_f32 v106, v106
    v_rcp_f32 v107, v107
    v_pk_mul_f32 v[96:97], v[96:97], v[220:221]
    v_pk_mul_f32 v[98:99], v[98:99], v[222:223]
    v_pk_mul_f32 v[104:105], v[104:105], v[228:229]
    v_pk_mul_f32 v[106:107], v[106:107], v[230:231]
    v_cvt_pk_bf16_f32 v112, v96, v97
    v_cvt_pk_bf16_f32 v113, v98, v99
    v_cvt_pk_bf16_f32 v114, v104, v105
    v_cvt_pk_bf16_f32 v115, v106, v107
    buffer_store_dwordx4 v[112:115], v1, s[28:31], s6 offen offset:0 sc1
    v_pk_mul_f32 v[100:101], v[224:225], v[224:225]
    v_pk_mul_f32 v[102:103], v[226:227], v[226:227]
    v_pk_mul_f32 v[108:109], v[232:233], v[232:233]
    v_pk_mul_f32 v[110:111], v[234:235], v[234:235]
    v_pk_fma_f32 v[100:101], v[100:101], s[4:5], s[4:5] op_sel:[0,0,1] op_sel_hi:[1,0,1]
L_w4:
    s_cbranch_execz L_wret
    v_pk_fma_f32 v[102:103], v[102:103], s[4:5], s[4:5] op_sel:[0,0,1] op_sel_hi:[1,0,1]
    v_pk_fma_f32 v[108:109], v[108:109], s[4:5], s[4:5] op_sel:[0,0,1] op_sel_hi:[1,0,1]
    v_pk_fma_f32 v[110:111], v[110:111], s[4:5], s[4:5] op_sel:[0,0,1] op_sel_hi:[1,0,1]
    v_pk_mul_f32 v[100:101], v[100:101], v[224:225]
    v_pk_mul_f32 v[102:103], v[102:103], v[226:227]
    v_pk_mul_f32 v[108:109], v[108:109], v[232:233]
    v_pk_mul_f32 v[110:111], v[110:111], v[234:235]
    v_exp_f32 v100, v100
    v_exp_f32 v101, v101
    v_exp_f32 v102, v102
    v_exp_f32 v103, v103
    v_exp_f32 v108, v108
    v_exp_f32 v109, v109
    v_exp_f32 v110, v110
    v_exp_f32 v111, v111
    v_pk_add_f32 v[100:101], v[100:101], 1.0 op_sel_hi:[1,0]
    v_pk_add_f32 v[102:103], v[102:103], 1.0 op_sel_hi:[1,0]
    v_pk_add_f32 v[108:109], v[108:109], 1.0 op_sel_hi:[1,0]
    v_pk_add_f32 v[110:111], v[110:111], 1.0 op_sel_hi:[1,0]
    v_rcp_f32 v100, v100
    v_rcp_f32 v101, v101
    buffer_load_dwordx4 v202, s[24:27], s74 offen offset:2048 lds
    v_rcp_f32 v102, v102
    v_rcp_f32 v103, v103
    v_rcp_f32 v108, v108
    v_rcp_f32 v109, v109
    v_rcp_f32 v110, v110
    v_rcp_f32 v111, v111
    v_pk_mul_f32 v[100:101], v[100:101], v[224:225]
    v_pk_mul_f32 v[102:103], v[102:103], v[226:227]
    v_pk_mul_f32 v[108:109], v[108:109], v[232:233]
    v_pk_mul_f32 v[110:111], v[110:111], v[234:235]
    v_cvt_pk_bf16_f32 v116, v100, v101
    v_cvt_pk_bf16_f32 v117, v102, v103
    v_cvt_pk_bf16_f32 v118, v108, v109
    v_cvt_pk_bf16_f32 v119, v110, v111
    buffer_store_dwordx4 v[116:119], v1, s[28:31], s6 offen offset:1024 sc1
    v_add_u32 v204, 0x10000, v212
    v_add_u32 v205, 0x10000, v213
    v_add_u32 v206, 0x10000, v214
    v_add_u32 v207, 0x10000, v215
    buffer_load_dwordx4 v203, s[24:27], s74 offen offset:3072 lds
    s_add_u32 m0, s77, 131072
    s_nop 0
    buffer_load_dwordx4 v4, s[8:11], s50 offen lds
    buffer_load_dwordx4 v5, s[8:11], s50 offen offset:1024 lds
    s_lshl_b32 s82, s67, 5
    s_add_u32 s82, s82, s68
    v_pk_fma_f32 v[28:29], v[90:91], v[72:73], v[28:29] op_sel_hi:[0,1,1]
    v_pk_fma_f32 v[30:31], v[90:91], v[74:75], v[30:31] op_sel_hi:[0,1,1]
    v_pk_fma_f32 v[28:29], v[28:29], v[90:91], s[86:87] op_sel:[0,1,0] op_sel_hi:[1,1,0]
    v_pk_fma_f32 v[30:31], v[30:31], v[90:91], s[86:87] op_sel:[0,1,0] op_sel_hi:[1,1,0]
    v_pk_fma_f32 v[32:33], v[92:93], v[72:73], v[32:33] op_sel_hi:[0,1,1]
    v_pk_fma_f32 v[34:35], v[92:93], v[74:75], v[34:35] op_sel_hi:[0,1,1]
    v_pk_fma_f32 v[32:33], v[32:33], v[92:93], s[86:87] op_sel:[0,1,0] op_sel_hi:[1,1,0]
    v_pk_fma_f32 v[34:35], v[34:35], v[92:93], s[86:87] op_sel:[0,1,0] op_sel_hi:[1,1,0]
    v_pk_fma_f32 v[36:37], v[94:95], v[72:73], v[36:37] op_sel_hi:[0,1,1]
    v_pk_fma_f32 v[38:39], v[94:95], v[74:75], v[38:39] op_sel_hi:[0,1,1]
    s_bfe_u32 s76, s56, 0x4000c
    s_mul_i32 s74, s76, 524288
    s_add_u32 m0, s78, 49152
    s_add_u32 s74, s74, s60
    buffer_load_dwordx4 v200, s[24:27], s74 offen lds
    v_pk_fma_f32 v[36:37], v[36:37], v[94:95], s[86:87] op_sel:[0,1,0] op_sel_hi:[1,1,0]
    v_pk_fma_f32 v[38:39], v[38:39], v[94:95], s[86:87] op_sel:[0,1,0] op_sel_hi:[1,1,0]
    v_pk_mul_f32 v[140:141], v[24:25], s[86:87] op_sel:[0,1] op_sel_hi:[1,1]
    v_pk_mul_f32 v[142:143], v[26:27], s[86:87] op_sel:[0,1] op_sel_hi:[1,1]
    v_exp_f32_e64 v140, v140 clamp
    v_exp_f32_e64 v141, v141 clamp
    v_exp_f32_e64 v142, v142 clamp
    buffer_load_dwordx4 v201, s[24:27], s74 offen offset:1024 lds
    v_exp_f32_e64 v143, v143 clamp
    v_max_f32 v24, s86, v24
    v_max_f32 v25, s86, v25
    v_max_f32 v26, s86, v26
    v_max_f32 v27, s86, v27
    v_pk_add_f32 v[24:25], v[24:25], v[140:141]
    v_pk_add_f32 v[26:27], v[26:27], v[142:143]
    v_cvt_pk_bf16_f32 v184, v24, v25
    v_cvt_pk_bf16_f32 v185, v26, v27
    buffer_load_dwordx4 v202, s[24:27], s74 offen offset:2048 lds
    v_pk_mul_f32 v[140:141], v[28:29], s[86:87] op_sel:[0,1] op_sel_hi:[1,1]
    v_pk_mul_f32 v[142:143], v[30:31], s[86:87] op_sel:[0,1] op_sel_hi:[1,1]
    v_exp_f32_e64 v140, v140 clamp
    v_exp_f32_e64 v141, v141 clamp
    v_exp_f32_e64 v142, v142 clamp
    v_exp_f32_e64 v143, v143 clamp
    buffer_load_dwordx4 v203, s[24:27], s74 offen offset:3072 lds
    v_max_f32 v28, s86, v28
    v_max_f32 v29, s86, v29
    v_max_f32 v30, s86, v30
    v_max_f32 v31, s86, v31
    v_pk_add_f32 v[28:29], v[28:29], v[140:141]
    v_pk_add_f32 v[30:31], v[30:31], v[142:143]
    v_cvt_pk_bf16_f32 v186, v28, v29
    v_cvt_pk_bf16_f32 v187, v30, v31
    v_pk_mul_f32 v[140:141], v[32:33], s[86:87] op_sel:[0,1] op_sel_hi:[1,1]
    v_pk_mul_f32 v[142:143], v[34:35], s[86:87] op_sel:[0,1] op_sel_hi:[1,1]
    s_bfe_u32 s76, s56, 0x40010
    s_mul_i32 s74, s76, 524288
    s_add_u32 m0, s78, 65536
    s_add_u32 s74, s74, s60
    buffer_load_dwordx4 v200, s[24:27], s74 offen lds
    v_permlane16_swap_b32 v184, v186
    v_permlane16_swap_b32 v185, v187
    v_exp_f32_e64 v140, v140 clamp
    v_exp_f32_e64 v141, v141 clamp
    v_exp_f32_e64 v142, v142 clamp
    v_exp_f32_e64 v143, v143 clamp
    buffer_load_dwordx4 v201, s[24:27], s74 offen offset:1024 lds
    v_max_f32 v32, s86, v32
    v_max_f32 v33, s86, v33
    v_max_f32 v34, s86, v34
    v_max_f32 v35, s86, v35
    v_pk_add_f32 v[32:33], v[32:33], v[140:141]
    v_pk_add_f32 v[34:35], v[34:35], v[142:143]
    v_cvt_pk_bf16_f32 v188, v32, v33
    v_cvt_pk_bf16_f32 v189, v34, v35
    v_pk_mul_f32 v[140:141], v[36:37], s[86:87] op_sel:[0,1] op_sel_hi:[1,1]
    v_pk_mul_f32 v[142:143], v[38:39], s[86:87] op_sel:[0,1] op_sel_hi:[1,1]
    buffer_load_dwordx4 v202, s[24:27], s74 offen offset:2048 lds
    v_exp_f32_e64 v140, v140 clamp
    v_exp_f32_e64 v141, v141 clamp
    v_exp_f32_e64 v142, v142 clamp
    v_exp_f32_e64 v143, v143 clamp
    v_max_f32 v36, s86, v36
    v_max_f32 v37, s86, v37
    buffer_load_dwordx4 v203, s[24:27], s74 offen offset:3072 lds
    v_max_f32 v38, s86, v38
    v_max_f32 v39, s86, v39
    v_pk_add_f32 v[36:37], v[36:37], v[140:141]
    v_pk_add_f32 v[38:39], v[38:39], v[142:143]
    v_cvt_pk_bf16_f32 v190, v36, v37
    v_cvt_pk_bf16_f32 v191, v38, v39
    s_nop 0
    v_permlane16_swap_b32 v188, v190
    v_permlane16_swap_b32 v189, v191
    s_waitcnt vmcnt(11)
    s_barrier
    s_cmp_lg_u32 s3, 0
    s_cbranch_scc1 L_sigm4
    s_lshl_b32 s4, s82, 7
    s_add_u32 s4, s4, 11010048
    buffer_store_dwordx4 v[180:183], v253, s[28:31], s4 offen sc1
L_sigm4:
    ds_read_b64_tr_b16 a[32:33], v212 offset:0
    ds_read_b64_tr_b16 a[34:35], v212 offset:2048
    ds_read_b64_tr_b16 a[36:37], v213 offset:0
    ds_read_b64_tr_b16 a[38:39], v213 offset:2048
    s_bfe_u32 s76, s56, 0x40014
    s_mul_i32 s74, s76, 524288
    s_add_u32 m0, s78, 81920
    s_add_u32 s74, s74, s60
    buffer_load_dwordx4 v200, s[24:27], s74 offen lds
    ds_read_b64_tr_b16 a[40:41], v214 offset:0
    ds_read_b64_tr_b16 a[42:43], v214 offset:2048
    ds_read_b64_tr_b16 a[44:45], v215 offset:0
    ds_read_b64_tr_b16 a[46:47], v215 offset:2048
    buffer_load_dwordx4 v201, s[24:27], s74 offen offset:1024 lds
    ds_read_b64_tr_b16 a[48:49], v212 offset:4096
    ds_read_b64_tr_b16 a[50:51], v212 offset:6144
    ds_read_b64_tr_b16 a[52:53], v213 offset:4096
    ds_read_b64_tr_b16 a[54:55], v213 offset:6144
    buffer_load_dwordx4 v202, s[24:27], s74 offen offset:2048 lds
    ds_read_b64_tr_b16 a[56:57], v214 offset:4096
    ds_read_b64_tr_b16 a[58:59], v214 offset:6144
    ds_read_b64_tr_b16 a[60:61], v215 offset:4096
    ds_read_b64_tr_b16 a[62:63], v215 offset:6144
    buffer_load_dwordx4 v203, s[24:27], s74 offen offset:3072 lds
    ds_read_b64_tr_b16 a[96:97], v212 offset:16384
    ds_read_b64_tr_b16 a[98:99], v212 offset:18432
    ds_read_b64_tr_b16 a[100:101], v213 offset:16384
    ds_read_b64_tr_b16 a[102:103], v213 offset:18432
    s_bfe_u32 s76, s56, 0x40018
    s_mul_i32 s74, s76, 524288
    s_add_u32 m0, s78, 98304
    s_add_u32 s74, s74, s60
    buffer_load_dwordx4 v200, s[24:27], s74 offen lds
    ds_read_b64_tr_b16 a[104:105], v214 offset:16384
    ds_read_b64_tr_b16 a[106:107], v214 offset:18432
    ds_read_b64_tr_b16 a[108:109], v215 offset:16384
    ds_read_b64_tr_b16 a[110:111], v215 offset:18432
    buffer_load_dwordx4 v201, s[24:27], s74 offen offset:1024 lds
    ds_read_b64_tr_b16 a[112:113], v212 offset:20480
    ds_read_b64_tr_b16 a[114:115], v212 offset:22528
    ds_read_b64_tr_b16 a[116:117], v213 offset:20480
    ds_read_b64_tr_b16 a[118:119], v213 offset:22528
    buffer_load_dwordx4 v202, s[24:27], s74 offen offset:2048 lds
    ds_read_b64_tr_b16 a[120:121], v214 offset:20480
    ds_read_b64_tr_b16 a[122:123], v214 offset:22528
    ds_read_b64_tr_b16 a[124:125], v215 offset:20480
    ds_read_b64_tr_b16 a[126:127], v215 offset:22528
    buffer_load_dwordx4 v203, s[24:27], s74 offen offset:3072 lds
    s_waitcnt vmcnt(12)
    s_waitcnt lgkmcnt(0)
    s_barrier
    ds_read_b64_tr_b16 a[128:129], v212 offset:32768
    ds_read_b64_tr_b16 a[130:131], v212 offset:34816
    ds_read_b64_tr_b16 a[132:133], v213 offset:32768
    ds_read_b64_tr_b16 a[134:135], v213 offset:34816
    s_bfe_u32 s76, s56, 0x4001c
    s_mul_i32 s74, s76, 524288
    s_add_u32 m0, s78, 114688
    s_add_u32 s74, s74, s60
    buffer_load_dwordx4 v200, s[24:27], s74 offen lds
    ds_read_b64_tr_b16 a[136:137], v214 offset:32768
    ds_read_b64_tr_b16 a[138:139], v214 offset:34816
    ds_read_b64_tr_b16 a[140:141], v215 offset:32768
    ds_read_b64_tr_b16 a[142:143], v215 offset:34816
    buffer_load_dwordx4 v201, s[24:27], s74 offen offset:1024 lds
    ds_read_b64_tr_b16 a[144:145], v212 offset:36864
    ds_read_b64_tr_b16 a[146:147], v212 offset:38912
    ds_read_b64_tr_b16 a[148:149], v213 offset:36864
    ds_read_b64_tr_b16 a[150:151], v213 offset:38912
    buffer_load_dwordx4 v202, s[24:27], s74 offen offset:2048 lds
    ds_read_b64_tr_b16 a[152:153], v214 offset:36864
    ds_read_b64_tr_b16 a[154:155], v214 offset:38912
    ds_read_b64_tr_b16 a[156:157], v215 offset:36864
    ds_read_b64_tr_b16 a[158:159], v215 offset:38912
    buffer_load_dwordx4 v203, s[24:27], s74 offen offset:3072 lds
    ds_read_b64_tr_b16 a[160:161], v212 offset:49152
    ds_read_b64_tr_b16 a[162:163], v212 offset:51200
    ds_read_b64_tr_b16 a[164:165], v213 offset:49152
    ds_read_b64_tr_b16 a[166:167], v213 offset:51200
    s_bfe_u32 s76, s57, 0x40000
    s_mul_i32 s74, s76, 524288
    s_add_u32 m0, s78, 0
    s_add_u32 s74, s74, s60
    buffer_load_dwordx4 v200, s[24:27], s74 offen lds
    ds_read_b64_tr_b16 a[168:169], v214 offset:49152
    ds_read_b64_tr_b16 a[170:171], v214 offset:51200
    ds_read_b64_tr_b16 a[172:173], v215 offset:49152
    ds_read_b64_tr_b16 a[174:175], v215 offset:51200
    buffer_load_dwordx4 v201, s[24:27], s74 offen offset:1024 lds
    ds_read_b64_tr_b16 a[176:177], v212 offset:53248
    ds_read_b64_tr_b16 a[178:179], v212 offset:55296
    ds_read_b64_tr_b16 a[180:181], v213 offset:53248
    ds_read_b64_tr_b16 a[182:183], v213 offset:55296
    buffer_load_dwordx4 v202, s[24:27], s74 offen offset:2048 lds
    ds_read_b64_tr_b16 a[184:185], v214 offset:53248
    ds_read_b64_tr_b16 a[186:187], v214 offset:55296
    ds_read_b64_tr_b16 a[188:189], v215 offset:53248
    ds_read_b64_tr_b16 a[190:191], v215 offset:55296
    buffer_load_dwordx4 v203, s[24:27], s74 offen offset:3072 lds
    v_and_b32 v16, 31, v0
    v_lshl_add_u32 v16, s46, 5, v16
    v_bfe_u32 v17, v16, 1, 3
    s_lshl_b32 s4, s47, 2
    v_xor_b32 v17, s4, v17
    v_lshlrev_b32 v17, 4, v17
    v_lshl_add_u32 v17, v16, 7, v17
    v_lshrrev_b32 v16, 5, v0
    v_lshlrev_b32 v16, 4, v16
    s_bfe_u32 s76, s57, 0x40004
    s_mul_i32 s74, s76, 524288
    s_add_u32 m0, s78, 16384
    s_add_u32 s74, s74, s60
    buffer_load_dwordx4 v200, s[24:27], s74 offen lds
    v_xor_b32 v17, v16, v17
    v_add_u32 v218, 131072, v17
    v_xor_b32 v17, 32, v218
    ds_read_b128 v[88:91], v218
    ds_read_b128 v[92:95], v17
    s_add_u32 s4, s77, 131072
    v_lshlrev_b32 v56, 16, v254
    v_mov_b32 v64, v56
    v_add_u32 v18, s4, v1
    s_nop 0
    v_permlane16_swap_b32 v56, v64
    v_mov_b32 v57, v56
    buffer_load_dwordx4 v201, s[24:27], s74 offen offset:1024 lds
    v_mov_b32 v58, v56
    v_mov_b32 v59, v56
    v_mov_b32 v60, v56
    v_mov_b32 v61, v56
    v_mov_b32 v62, v56
    v_mov_b32 v63, v56
    v_mov_b32 v65, v64
    v_mov_b32 v66, v64
    buffer_load_dwordx4 v202, s[24:27], s74 offen offset:2048 lds
    v_mov_b32 v67, v64
    v_mov_b32 v68, v64
    v_mov_b32 v69, v64
    v_mov_b32 v70, v64
    v_mov_b32 v71, v64
    s_waitcnt lgkmcnt(0)
    v_lshlrev_b32 v128, 16, v88
    v_and_b32 v129, 0xffff0000, v88
    v_lshlrev_b32 v130, 16, v89
    buffer_load_dwordx4 v203, s[24:27], s74 offen offset:3072 lds
    v_and_b32 v131, 0xffff0000, v89
    v_lshlrev_b32 v132, 16, v90
    v_and_b32 v133, 0xffff0000, v90
    v_lshlrev_b32 v134, 16, v91
    v_and_b32 v135, 0xffff0000, v91
    v_lshlrev_b32 v136, 16, v92
    v_and_b32 v137, 0xffff0000, v92
    v_lshlrev_b32 v138, 16, v93
    v_and_b32 v139, 0xffff0000, v93
    v_lshlrev_b32 v140, 16, v94
    v_and_b32 v141, 0xffff0000, v94
    v_lshlrev_b32 v142, 16, v95
    v_and_b32 v143, 0xffff0000, v95
    s_waitcnt vmcnt(16)
    s_barrier
    ds_read_b64_tr_b16 a[192:193], v204 offset:0
    ds_read_b64_tr_b16 a[194:195], v204 offset:2048
    ds_read_b64_tr_b16 a[196:197], v205 offset:0
    ds_read_b64_tr_b16 a[198:199], v205 offset:2048
    s_bfe_u32 s76, s57, 0x40008
    s_mul_i32 s74, s76, 524288
    s_add_u32 m0, s78, 32768
    s_add_u32 s74, s74, s60
    buffer_load_dwordx4 v200, s[24:27], s74 offen lds
    ds_read_b64_tr_b16 a[200:201], v206 offset:0
    ds_read_b64_tr_b16 a[202:203], v206 offset:2048
    ds_read_b64_tr_b16 a[204:205], v207 offset:0
    ds_read_b64_tr_b16 a[206:207], v207 offset:2048
    buffer_load_dwordx4 v201, s[24:27], s74 offen offset:1024 lds
    ds_read_b64_tr_b16 a[208:209], v204 offset:4096
    ds_read_b64_tr_b16 a[210:211], v204 offset:6144
    ds_read_b64_tr_b16 a[212:213], v205 offset:4096
    ds_read_b64_tr_b16 a[214:215], v205 offset:6144
    buffer_load_dwordx4 v202, s[24:27], s74 offen offset:2048 lds
    ds_read_b64_tr_b16 a[216:217], v206 offset:4096
    ds_read_b64_tr_b16 a[218:219], v206 offset:6144
    ds_read_b64_tr_b16 a[220:221], v207 offset:4096
    ds_read_b64_tr_b16 a[222:223], v207 offset:6144
    buffer_load_dwordx4 v203, s[24:27], s74 offen offset:3072 lds
    ds_read_b64_tr_b16 a[224:225], v204 offset:16384
    ds_read_b64_tr_b16 a[226:227], v204 offset:18432
    ds_read_b64_tr_b16 a[228:229], v205 offset:16384
    ds_read_b64_tr_b16 a[230:231], v205 offset:18432
    s_bfe_u32 s76, s57, 0x4000c
    s_mul_i32 s74, s76, 524288
    s_add_u32 m0, s78, 49152
    s_add_u32 s74, s74, s60
    buffer_load_dwordx4 v200, s[24:27], s74 offen lds
    ds_read_b64_tr_b16 a[232:233], v206 offset:16384
    ds_read_b64_tr_b16 a[234:235], v206 offset:18432
    ds_read_b64_tr_b16 a[236:237], v207 offset:16384
    ds_read_b64_tr_b16 a[238:239], v207 offset:18432
    buffer_load_dwordx4 v201, s[24:27], s74 offen offset:1024 lds
    ds_read_b64_tr_b16 a[240:241], v204 offset:20480
    ds_read_b64_tr_b16 a[242:243], v204 offset:22528
    ds_read_b64_tr_b16 a[244:245], v205 offset:20480
    ds_read_b64_tr_b16 a[246:247], v205 offset:22528
    buffer_load_dwordx4 v202, s[24:27], s74 offen offset:2048 lds
    ds_read_b64_tr_b16 a[248:249], v206 offset:20480
    ds_read_b64_tr_b16 a[250:251], v206 offset:22528
    ds_read_b64_tr_b16 a[252:253], v207 offset:20480
    ds_read_b64_tr_b16 a[254:255], v207 offset:22528
    buffer_load_dwordx4 v203, s[24:27], s74 offen offset:3072 lds
    s_waitcnt vmcnt(16)
    s_waitcnt lgkmcnt(0)
L_common:
    s_barrier
    ds_read_b64_tr_b16 v[24:25], v204 offset:32768
    ds_read_b64_tr_b16 v[26:27], v204 offset:34816
    ds_read_b64_tr_b16 v[28:29], v205 offset:32768
    ds_read_b64_tr_b16 v[30:31], v205 offset:34816
    s_bfe_u32 s76, s57, 0x40010
    s_mul_i32 s74, s76, 524288
    s_add_u32 m0, s78, 65536
    s_add_u32 s74, s74, s60
    buffer_load_dwordx4 v200, s[24:27], s74 offen lds
    ds_read_b64_tr_b16 v[32:33], v206 offset:32768
    ds_read_b64_tr_b16 v[34:35], v206 offset:34816
    ds_read_b64_tr_b16 v[36:37], v207 offset:32768
    ds_read_b64_tr_b16 v[38:39], v207 offset:34816
    buffer_load_dwordx4 v201, s[24:27], s74 offen offset:1024 lds
    ds_read_b64_tr_b16 v[40:41], v204 offset:36864
    ds_read_b64_tr_b16 v[42:43], v204 offset:38912
    ds_read_b64_tr_b16 v[44:45], v205 offset:36864
    ds_read_b64_tr_b16 v[46:47], v205 offset:38912
    buffer_load_dwordx4 v202, s[24:27], s74 offen offset:2048 lds
    ds_read_b64_tr_b16 v[48:49], v206 offset:36864
    ds_read_b64_tr_b16 v[50:51], v206 offset:38912
    ds_read_b64_tr_b16 v[52:53], v207 offset:36864
    ds_read_b64_tr_b16 v[54:55], v207 offset:38912
    buffer_load_dwordx4 v203, s[24:27], s74 offen offset:3072 lds
    ds_read_b64_tr_b16 v[96:97], v204 offset:49152
    ds_read_b64_tr_b16 v[98:99], v204 offset:51200
    ds_read_b64_tr_b16 v[100:101], v205 offset:49152
    ds_read_b64_tr_b16 v[102:103], v205 offset:51200
    s_bfe_u32 s76, s57, 0x40014
    s_mul_i32 s74, s76, 524288
    s_add_u32 m0, s78, 81920
    s_add_u32 s74, s74, s60
    buffer_load_dwordx4 v200, s[24:27], s74 offen lds
    ds_read_b64_tr_b16 v[104:105], v206 offset:49152
    ds_read_b64_tr_b16 v[106:107], v206 offset:51200
    ds_read_b64_tr_b16 v[108:109], v207 offset:49152
    ds_read_b64_tr_b16 v[110:111], v207 offset:51200
    buffer_load_dwordx4 v201, s[24:27], s74 offen offset:1024 lds
    ds_read_b64_tr_b16 v[112:113], v204 offset:53248
    ds_read_b64_tr_b16 v[114:115], v204 offset:55296
    ds_read_b64_tr_b16 v[116:117], v205 offset:53248
    ds_read_b64_tr_b16 v[118:119], v205 offset:55296
    buffer_load_dwordx4 v202, s[24:27], s74 offen offset:2048 lds
    ds_read_b64_tr_b16 v[120:121], v206 offset:53248
    ds_read_b64_tr_b16 v[122:123], v206 offset:55296
    ds_read_b64_tr_b16 v[124:125], v207 offset:53248
    ds_read_b64_tr_b16 v[126:127], v207 offset:55296
    buffer_load_dwordx4 v203, s[24:27], s74 offen offset:3072 lds
    s_waitcnt vmcnt(16)
    s_waitcnt lgkmcnt(0)
    s_barrier
    s_lshl_b32 s4, s85, 2
    s_add_u32 s4, s4, s3
    s_lshl_b32 s4, s4, 7
    s_lshl_b32 s5, s65, 15
    s_add_u32 s4, s4, s5
    s_add_u32 s81, s4, 10747904
    v_mov_b32 v19, 0
    buffer_load_dword v252, v19, s[28:31], s81 offen sc1
    ds_read_b64_tr_b16 v[148:149], v212 offset:0
    ds_read_b64_tr_b16 v[150:151], v212 offset:2048
    ds_read_b64_tr_b16 v[152:153], v213 offset:0
    ds_read_b64_tr_b16 v[154:155], v213 offset:2048
    s_bfe_u32 s76, s54, 0x40000
    s_mul_i32 s74, s76, 131072
    s_add_u32 m0, s78, 98304
    s_add_u32 s74, s74, s59
    buffer_load_dwordx4 v196, s[16:19], s74 offen lds
    ds_read_b64_tr_b16 v[156:157], v214 offset:0
    ds_read_b64_tr_b16 v[158:159], v214 offset:2048
    ds_read_b64_tr_b16 v[160:161], v215 offset:0
    ds_read_b64_tr_b16 v[162:163], v215 offset:2048
    buffer_load_dwordx4 v197, s[16:19], s74 offen offset:1024 lds
    ds_read_b64_tr_b16 v[164:165], v212 offset:4096
    ds_read_b64_tr_b16 v[166:167], v212 offset:6144
    ds_read_b64_tr_b16 v[168:169], v213 offset:4096
    ds_read_b64_tr_b16 v[170:171], v213 offset:6144
    buffer_load_dwordx4 v198, s[16:19], s74 offen offset:2048 lds
    ds_read_b64_tr_b16 v[172:173], v214 offset:4096
    ds_read_b64_tr_b16 v[174:175], v214 offset:6144
    ds_read_b64_tr_b16 v[176:177], v215 offset:4096
    ds_read_b64_tr_b16 v[178:179], v215 offset:6144
    buffer_load_dwordx4 v199, s[16:19], s74 offen offset:3072 lds
    ds_read_b64_tr_b16 v[220:221], v212 offset:16384
    ds_read_b64_tr_b16 v[222:223], v212 offset:18432
    ds_read_b64_tr_b16 v[224:225], v213 offset:16384
    ds_read_b64_tr_b16 v[226:227], v213 offset:18432
    s_bfe_u32 s76, s54, 0x40004
    s_mul_i32 s74, s76, 131072
    s_add_u32 m0, s78, 114688
    s_add_u32 s74, s74, s59
    buffer_load_dwordx4 v196, s[16:19], s74 offen lds
    ds_read_b64_tr_b16 v[228:229], v214 offset:16384
    ds_read_b64_tr_b16 v[230:231], v214 offset:18432
    ds_read_b64_tr_b16 v[232:233], v215 offset:16384
    ds_read_b64_tr_b16 v[234:235], v215 offset:18432
    buffer_load_dwordx4 v197, s[16:19], s74 offen offset:1024 lds
    ds_read_b64_tr_b16 v[236:237], v212 offset:20480
    ds_read_b64_tr_b16 v[238:239], v212 offset:22528
    ds_read_b64_tr_b16 v[240:241], v213 offset:20480
    ds_read_b64_tr_b16 v[242:243], v213 offset:22528
    buffer_load_dwordx4 v198, s[16:19], s74 offen offset:2048 lds
    ds_read_b64_tr_b16 v[244:245], v214 offset:20480
    ds_read_b64_tr_b16 v[246:247], v214 offset:22528
    ds_read_b64_tr_b16 v[248:249], v215 offset:20480
    ds_read_b64_tr_b16 v[250:251], v215 offset:22528
    buffer_load_dwordx4 v199, s[16:19], s74 offen offset:3072 lds
    s_waitcnt lgkmcnt(0)
    s_barrier
    s_waitcnt vmcnt(8)
    v_cmp_ne_u32 vcc, s64, v252
    s_cbranch_vccz L_okm5
    s_mov_b32 s79, 100000
L_okm5s:
    buffer_load_dword v252, v19, s[28:31], s81 offen sc1
    s_waitcnt vmcnt(0)
    v_cmp_ne_u32 vcc, s64, v252
    s_cbranch_vccz L_okm5
    s_sub_u32 s79, s79, 1
    s_cmp_lg_u32 s79, 0
    s_cbranch_scc1 L_okm5s
L_okm5:
    s_lshl_b32 s4, s85, 2
    s_add_u32 s4, s4, s3
    s_lshl_b32 s4, s4, 10
    s_add_u32 s83, s4, s73
    s_add_u32 s83, s83, 6291456
    s_add_u32 s4, s4, 4194304
    buffer_load_dwordx4 v[20:23], v1, s[28:31], s4 offen sc1
    v_min_u32 v19, 27, v0
    v_lshlrev_b32 v19, 7, v19
    s_lshl_b32 s4, s70, 12
    s_lshl_b32 s5, s65, 15
    s_add_u32 s4, s4, s5
    s_add_u32 s81, s4, 11010048
    s_cmp_lg_u32 s3, 1
    s_cbranch_scc1 L_pim6
    buffer_load_dword v252, v19, s[28:31], s81 offen sc1
L_pim6:
    s_bfe_u32 s76, s54, 0x40008
    s_mul_i32 s74, s76, 131072
    s_add_u32 m0, s78, 0
    s_add_u32 s74, s74, s59
    buffer_load_dwordx4 v196, s[16:19], s74 offen lds
    buffer_load_dwordx4 v197, s[16:19], s74 offen offset:1024 lds
    buffer_load_dwordx4 v198, s[16:19], s74 offen offset:2048 lds
    buffer_load_dwordx4 v199, s[16:19], s74 offen offset:3072 lds
    s_bfe_u32 s76, s54, 0x4000c
    s_mul_i32 s74, s76, 131072
    s_add_u32 m0, s78, 16384
    s_add_u32 s74, s74, s59
    buffer_load_dwordx4 v196, s[16:19], s74 offen lds
    buffer_load_dwordx4 v197, s[16:19], s74 offen offset:1024 lds
    buffer_load_dwordx4 v198, s[16:19], s74 offen offset:2048 lds
    buffer_load_dwordx4 v199, s[16:19], s74 offen offset:3072 lds
    s_cmp_lg_u32 s3, 1
    s_cbranch_scc1 L_okm7
    s_waitcnt vmcnt(8)
    v_cmp_ne_u32 vcc, s64, v252
    s_cbranch_vccz L_okm7
    s_mov_b32 s79, 100000
L_okm7s:
    buffer_load_dword v252, v19, s[28:31], s81 offen sc1
    s_waitcnt vmcnt(0)
    v_cmp_ne_u32 vcc, s64, v252
    s_cbranch_vccz L_okm7
    s_sub_u32 s79, s79, 1
    s_cmp_lg_u32 s79, 0
    s_cbranch_scc1 L_okm7s
L_okm7:
    s_barrier
    s_bfe_u32 s76, s56, 0x40000
    s_lshl_b32 s75, s76, 13
    s_add_u32 s75, s75, s63
    buffer_load_dwordx4 a[64:67], v1, s[28:31], s75 offen offset:0 sc1
    buffer_load_dwordx4 a[68:71], v1, s[28:31], s75 offen offset:1024 sc1
    buffer_load_dwordx4 a[72:75], v1, s[28:31], s75 offen offset:2048 sc1
    buffer_load_dwordx4 a[76:79], v1, s[28:31], s75 offen offset:3072 sc1
    s_bfe_u32 s76, s56, 0x40004
    s_lshl_b32 s75, s76, 13
    s_add_u32 s75, s75, s63
    buffer_load_dwordx4 a[80:83], v1, s[28:31], s75 offen offset:0 sc1
    buffer_load_dwordx4 a[84:87], v1, s[28:31], s75 offen offset:1024 sc1
    buffer_load_dwordx4 a[88:91], v1, s[28:31], s75 offen offset:2048 sc1
    buffer_load_dwordx4 a[92:95], v1, s[28:31], s75 offen offset:3072 sc1
    s_waitcnt vmcnt(16)
    v_mfma_f32_32x32x16_bf16 v[72:87], v[20:23], v[184:187], 0
    s_nop 11
    v_add_f32 v80, 0x358637bd, v80
    v_rcp_f32 v80, v80
    s_add_u32 s83, s83, 0
    v_mul_f32 v72, v72, v80
    v_mul_f32 v73, v73, v80
    v_mul_f32 v74, v74, v80
    v_mul_f32 v75, v75, v80
    v_mul_f32 v76, v76, v80
    v_mul_f32 v77, v77, v80
    v_mul_f32 v78, v78, v80
    v_mul_f32 v79, v79, v80
    v_cvt_pk_bf16_f32 v184, v72, v73
    v_cvt_pk_bf16_f32 v185, v74, v75
    v_cvt_pk_bf16_f32 v186, v76, v77
    v_cvt_pk_bf16_f32 v187, v78, v79
    buffer_store_dwordx4 v[184:187], v1, s[28:31], s83 offen sc1
    v_mfma_f32_32x32x16_bf16 v[72:87], v[20:23], v[188:191], 0
    s_nop 11
    v_add_f32 v80, 0x358637bd, v80
    v_rcp_f32 v80, v80
    s_add_u32 s83, s83, 32768
    v_mul_f32 v72, v72, v80
    v_mul_f32 v73, v73, v80
    v_mul_f32 v74, v74, v80
    v_mul_f32 v75, v75, v80
    v_mul_f32 v76, v76, v80
    v_mul_f32 v77, v77, v80
    v_mul_f32 v78, v78, v80
    v_mul_f32 v79, v79, v80
    v_cvt_pk_bf16_f32 v188, v72, v73
    v_cvt_pk_bf16_f32 v189, v74, v75
    v_cvt_pk_bf16_f32 v190, v76, v77
    v_cvt_pk_bf16_f32 v191, v78, v79
    buffer_store_dwordx4 v[188:191], v1, s[28:31], s83 offen sc1
    s_lshl_b32 s82, s44, 3
    s_add_u32 s82, s82, s45
    s_bfe_u32 s76, s56, 0x40008
    s_lshl_b32 s75, s76, 13
    s_add_u32 s75, s75, s63
    buffer_load_dwordx4 a[0:3], v1, s[28:31], s75 offen offset:0 sc1
    buffer_load_dwordx4 a[4:7], v1, s[28:31], s75 offen offset:1024 sc1
    s_waitcnt vmcnt(10)
    v_mfma_f32_16x16x32_bf16 v[56:59], a[64:67], a[32:35], v[56:59]
    v_mfma_f32_16x16x32_bf16 v[60:63], a[68:71], a[32:35], v[60:63]
    buffer_load_dwordx4 a[8:11], v1, s[28:31], s75 offen offset:2048 sc1
    v_mfma_f32_16x16x32_bf16 v[64:67], a[64:67], a[36:39], v[64:67]
    v_mfma_f32_16x16x32_bf16 v[68:71], a[68:71], a[36:39], v[68:71]
    v_mfma_f32_16x16x32_bf16 v[72:75], a[64:67], a[40:43], 0
    v_mfma_f32_16x16x32_bf16 v[76:79], a[68:71], a[40:43], 0
    buffer_load_dwordx4 a[12:15], v1, s[28:31], s75 offen offset:3072 sc1
    v_mfma_f32_16x16x32_bf16 v[80:83], a[64:67], a[44:47], 0
    v_mfma_f32_16x16x32_bf16 v[84:87], a[68:71], a[44:47], 0
    s_waitcnt vmcnt(10)
    v_mfma_f32_16x16x32_bf16 v[56:59], a[72:75], a[48:51], v[56:59]
    v_mfma_f32_16x16x32_bf16 v[60:63], a[76:79], a[48:51], v[60:63]
    s_bfe_u32 s76, s56, 0x4000c
    s_lshl_b32 s75, s76, 13
    s_add_u32 s75, s75, s63
    buffer_load_dwordx4 a[16:19], v1, s[28:31], s75 offen offset:0 sc1
    v_mfma_f32_16x16x32_bf16 v[64:67], a[72:75], a[52:55], v[64:67]
    v_mfma_f32_16x16x32_bf16 v[68:71], a[76:79], a[52:55], v[68:71]
    v_mfma_f32_16x16x32_bf16 v[72:75], a[72:75], a[56:59], v[72:75]
    v_mfma_f32_16x16x32_bf16 v[76:79], a[76:79], a[56:59], v[76:79]
    buffer_load_dwordx4 a[20:23], v1, s[28:31], s75 offen offset:1024 sc1
    v_mfma_f32_16x16x32_bf16 v[80:83], a[72:75], a[60:63], v[80:83]
L_w5:
    s_cbranch_execz L_wret
    v_mfma_f32_16x16x32_bf16 v[84:87], a[76:79], a[60:63], v[84:87]
    s_waitcnt vmcnt(10)
    v_mfma_f32_16x16x32_bf16 v[56:59], a[80:83], a[96:99], v[56:59]
    v_mfma_f32_16x16x32_bf16 v[60:63], a[84:87], a[96:99], v[60:63]
    buffer_load_dwordx4 a[24:27], v1, s[28:31], s75 offen offset:2048 sc1
    v_mfma_f32_16x16x32_bf16 v[64:67], a[80:83], a[100:103], v[64:67]
    v_mfma_f32_16x16x32_bf16 v[68:71], a[84:87], a[100:103], v[68:71]
    v_mfma_f32_16x16x32_bf16 v[72:75], a[80:83], a[104:107], v[72:75]
    v_mfma_f32_16x16x32_bf16 v[76:79], a[84:87], a[104:107], v[76:79]
    buffer_load_dwordx4 a[28:31], v1, s[28:31], s75 offen offset:3072 sc1
    v_mfma_f32_16x16x32_bf16 v[80:83], a[80:83], a[108:111], v[80:83]
    v_mfma_f32_16x16x32_bf16 v[84:87], a[84:87], a[108:111], v[84:87]
    s_waitcnt vmcnt(10)
    v_mfma_f32_16x16x32_bf16 v[56:59], a[88:91], a[112:115], v[56:59]
    v_mfma_f32_16x16x32_bf16 v[60:63], a[92:95], a[112:115], v[60:63]
    s_bfe_u32 s76, s56, 0x40010
    s_lshl_b32 s75, s76, 13
    s_add_u32 s75, s75, s63
    buffer_load_dwordx4 a[32:35], v1, s[28:31], s75 offen offset:0 sc1
    v_mfma_f32_16x16x32_bf16 v[64:67], a[88:91], a[116:119], v[64:67]
    v_mfma_f32_16x16x32_bf16 v[68:71], a[92:95], a[116:119], v[68:71]
    v_mfma_f32_16x16x32_bf16 v[72:75], a[88:91], a[120:123], v[72:75]
    v_mfma_f32_16x16x32_bf16 v[76:79], a[92:95], a[120:123], v[76:79]
    buffer_load_dwordx4 a[36:39], v1, s[28:31], s75 offen offset:1024 sc1
    v_mfma_f32_16x16x32_bf16 v[80:83], a[88:91], a[124:127], v[80:83]
    v_mfma_f32_16x16x32_bf16 v[84:87], a[92:95], a[124:127], v[84:87]
    buffer_load_dwordx4 a[40:43], v1, s[28:31], s75 offen offset:2048 sc1
    buffer_load_dwordx4 a[44:47], v1, s[28:31], s75 offen offset:3072 sc1
    s_waitcnt vmcnt(10)
    v_mfma_f32_16x16x32_bf16 v[56:59], a[0:3], a[128:131], v[56:59]
    ds_read_b64_tr_b16 a[96:97], v212 offset:32768
    v_mfma_f32_16x16x32_bf16 v[60:63], a[4:7], a[128:131], v[60:63]
    ds_read_b64_tr_b16 a[98:99], v212 offset:34816
    s_bfe_u32 s76, s56, 0x40014
    s_lshl_b32 s75, s76, 13
    s_add_u32 s75, s75, s63
    buffer_load_dwordx4 a[48:51], v1, s[28:31], s75 offen offset:0 sc1
    v_mfma_f32_16x16x32_bf16 v[64:67], a[0:3], a[132:135], v[64:67]
    ds_read_b64_tr_b16 a[100:101], v213 offset:32768
    v_mfma_f32_16x16x32_bf16 v[68:71], a[4:7], a[132:135], v[68:71]
    ds_read_b64_tr_b16 a[102:103], v213 offset:34816
    v_mfma_f32_16x16x32_bf16 v[72:75], a[0:3], a[136:139], v[72:75]
    ds_read_b64_tr_b16 a[104:105], v214 offset:32768
    v_mfma_f32_16x16x32_bf16 v[76:79], a[4:7], a[136:139], v[76:79]
    ds_read_b64_tr_b16 a[106:107], v214 offset:34816
    buffer_load_dwordx4 a[52:55], v1, s[28:31], s75 offen offset:1024 sc1
    v_mfma_f32_16x16x32_bf16 v[80:83], a[0:3], a[140:143], v[80:83]
    ds_read_b64_tr_b16 a[108:109], v215 offset:32768
    v_mfma_f32_16x16x32_bf16 v[84:87], a[4:7], a[140:143], v[84:87]
    ds_read_b64_tr_b16 a[110:111], v215 offset:34816
    s_waitcnt vmcnt(10)
    v_mfma_f32_16x16x32_bf16 v[56:59], a[8:11], a[144:147], v[56:59]
    ds_read_b64_tr_b16 a[112:113], v212 offset:36864
    v_mfma_f32_16x16x32_bf16 v[60:63], a[12:15], a[144:147], v[60:63]
    ds_read_b64_tr_b16 a[114:115], v212 offset:38912
    buffer_load_dwordx4 a[56:59], v1, s[28:31], s75 offen offset:2048 sc1
    v_mfma_f32_16x16x32_bf16 v[64:67], a[8:11], a[148:151], v[64:67]
    ds_read_b64_tr_b16 a[116:117], v213 offset:36864
    v_mfma_f32_16x16x32_bf16 v[68:71], a[12:15], a[148:151], v[68:71]
    ds_read_b64_tr_b16 a[118:119], v213 offset:38912
    v_mfma_f32_16x16x32_bf16 v[72:75], a[8:11], a[152:155], v[72:75]
    ds_read_b64_tr_b16 a[120:121], v214 offset:36864
    v_mfma_f32_16x16x32_bf16 v[76:79], a[12:15], a[152:155], v[76:79]
    ds_read_b64_tr_b16 a[122:123], v214 offset:38912
    buffer_load_dwordx4 a[60:63], v1, s[28:31], s75 offen offset:3072 sc1
    v_mfma_f32_16x16x32_bf16 v[80:83], a[8:11], a[156:159], v[80:83]
    ds_read_b64_tr_b16 a[124:125], v215 offset:36864
    v_mfma_f32_16x16x32_bf16 v[84:87], a[12:15], a[156:159], v[84:87]
    ds_read_b64_tr_b16 a[126:127], v215 offset:38912
    s_barrier
    s_cmp_lg_u32 s3, 0
    s_cbranch_scc1 L_sigm8
    s_lshl_b32 s4, s82, 7
    s_add_u32 s4, s4, 10518528
    s_mov_b64 exec, 0xff
    buffer_store_dwordx4 v[180:183], v253, s[28:31], s4 offen sc1
    s_mov_b64 exec, -1
L_sigm8:
    s_waitcnt vmcnt(10)
    v_mfma_f32_16x16x32_bf16 v[56:59], a[16:19], a[160:163], v[56:59]
    ds_read_b64_tr_b16 a[128:129], v212 offset:49152
    v_mfma_f32_16x16x32_bf16 v[60:63], a[20:23], a[160:163], v[60:63]
    ds_read_b64_tr_b16 a[130:131], v212 offset:51200
    s_bfe_u32 s76, s56, 0x40018
    s_lshl_b32 s75, s76, 13
    s_add_u32 s75, s75, s63
    buffer_load_dwordx4 a[64:67], v1, s[28:31], s75 offen offset:0 sc1
    v_mfma_f32_16x16x32_bf16 v[64:67], a[16:19], a[164:167], v[64:67]
    ds_read_b64_tr_b16 a[132:133], v213 offset:49152
    v_mfma_f32_16x16x32_bf16 v[68:71], a[20:23], a[164:167], v[68:71]
    ds_read_b64_tr_b16 a[134:135], v213 offset:51200
    v_mfma_f32_16x16x32_bf16 v[72:75], a[16:19], a[168:171], v[72:75]
    ds_read_b64_tr_b16 a[136:137], v214 offset:49152
    v_mfma_f32_16x16x32_bf16 v[76:79], a[20:23], a[168:171], v[76:79]
    ds_read_b64_tr_b16 a[138:139], v214 offset:51200
    buffer_load_dwordx4 a[68:71], v1, s[28:31], s75 offen offset:1024 sc1
    v_mfma_f32_16x16x32_bf16 v[80:83], a[16:19], a[172:175], v[80:83]
    ds_read_b64_tr_b16 a[140:141], v215 offset:49152
    v_mfma_f32_16x16x32_bf16 v[84:87], a[20:23], a[172:175], v[84:87]
    ds_read_b64_tr_b16 a[142:143], v215 offset:51200
    s_waitcnt vmcnt(10)
    v_mfma_f32_16x16x32_bf16 v[56:59], a[24:27], a[176:179], v[56:59]
    ds_read_b64_tr_b16 a[144:145], v212 offset:53248
    v_mfma_f32_16x16x32_bf16 v[60:63], a[28:31], a[176:179], v[60:63]
    ds_read_b64_tr_b16 a[146:147], v212 offset:55296
    buffer_load_dwordx4 a[72:75], v1, s[28:31], s75 offen offset:2048 sc1
    v_mfma_f32_16x16x32_bf16 v[64:67], a[24:27], a[180:183], v[64:67]
    ds_read_b64_tr_b16 a[148:149], v213 offset:53248
    v_mfma_f32_16x16x32_bf16 v[68:71], a[28:31], a[180:183], v[68:71]
    ds_read_b64_tr_b16 a[150:151], v213 offset:55296
    v_mfma_f32_16x16x32_bf16 v[72:75], a[24:27], a[184:187], v[72:75]
    ds_read_b64_tr_b16 a[152:153], v214 offset:53248
    v_mfma_f32_16x16x32_bf16 v[76:79], a[28:31], a[184:187], v[76:79]
    ds_read_b64_tr_b16 a[154:155], v214 offset:55296
    buffer_load_dwordx4 a[76:79], v1, s[28:31], s75 offen offset:3072 sc1
    v_mfma_f32_16x16x32_bf16 v[80:83], a[24:27], a[188:191], v[80:83]
    ds_read_b64_tr_b16 a[156:157], v215 offset:53248
    v_mfma_f32_16x16x32_bf16 v[84:87], a[28:31], a[188:191], v[84:87]
    ds_read_b64_tr_b16 a[158:159], v215 offset:55296
    s_waitcnt vmcnt(10)
    v_mfma_f32_16x16x32_bf16 v[56:59], a[32:35], a[192:195], v[56:59]
    ds_read_b64_tr_b16 a[160:161], v204 offset:0
    v_mfma_f32_16x16x32_bf16 v[60:63], a[36:39], a[192:195], v[60:63]
    ds_read_b64_tr_b16 a[162:163], v204 offset:2048
    s_bfe_u32 s76, s56, 0x4001c
    s_lshl_b32 s75, s76, 13
    s_add_u32 s75, s75, s63
    buffer_load_dwordx4 a[80:83], v1, s[28:31], s75 offen offset:0 sc1
    v_mfma_f32_16x16x32_bf16 v[64:67], a[32:35], a[196:199], v[64:67]
    ds_read_b64_tr_b16 a[164:165], v205 offset:0
    v_mfma_f32_16x16x32_bf16 v[68:71], a[36:39], a[196:199], v[68:71]
    ds_read_b64_tr_b16 a[166:167], v205 offset:2048
    v_mfma_f32_16x16x32_bf16 v[72:75], a[32:35], a[200:203], v[72:75]
    ds_read_b64_tr_b16 a[168:169], v206 offset:0
    v_mfma_f32_16x16x32_bf16 v[76:79], a[36:39], a[200:203], v[76:79]
    ds_read_b64_tr_b16 a[170:171], v206 offset:2048
    buffer_load_dwordx4 a[84:87], v1, s[28:31], s75 offen offset:1024 sc1
    v_mfma_f32_16x16x32_bf16 v[80:83], a[32:35], a[204:207], v[80:83]
    ds_read_b64_tr_b16 a[172:173], v207 offset:0
    v_mfma_f32_16x16x32_bf16 v[84:87], a[36:39], a[204:207], v[84:87]
    ds_read_b64_tr_b16 a[174:175], v207 offset:2048
    s_waitcnt vmcnt(10)
    v_mfma_f32_16x16x32_bf16 v[56:59], a[40:43], a[208:211], v[56:59]
    ds_read_b64_tr_b16 a[176:177], v204 offset:4096
    v_mfma_f32_16x16x32_bf16 v[60:63], a[44:47], a[208:211], v[60:63]
    ds_read_b64_tr_b16 a[178:179], v204 offset:6144
    buffer_load_dwordx4 a[88:91], v1, s[28:31], s75 offen offset:2048 sc1
    v_mfma_f32_16x16x32_bf16 v[64:67], a[40:43], a[212:215], v[64:67]
    ds_read_b64_tr_b16 a[180:181], v205 offset:4096
    v_mfma_f32_16x16x32_bf16 v[68:71], a[44:47], a[212:215], v[68:71]
    ds_read_b64_tr_b16 a[182:183], v205 offset:6144
    v_mfma_f32_16x16x32_bf16 v[72:75], a[40:43], a[216:219], v[72:75]
    ds_read_b64_tr_b16 a[184:185], v206 offset:4096
    v_mfma_f32_16x16x32_bf16 v[76:79], a[44:47], a[216:219], v[76:79]
    ds_read_b64_tr_b16 a[186:187], v206 offset:6144
    buffer_load_dwordx4 a[92:95], v1, s[28:31], s75 offen offset:3072 sc1
    v_mfma_f32_16x16x32_bf16 v[80:83], a[40:43], a[220:223], v[80:83]
    ds_read_b64_tr_b16 a[188:189], v207 offset:4096
    v_mfma_f32_16x16x32_bf16 v[84:87], a[44:47], a[220:223], v[84:87]
    ds_read_b64_tr_b16 a[190:191], v207 offset:6144
    s_waitcnt vmcnt(10)
    v_mfma_f32_16x16x32_bf16 v[56:59], a[48:51], a[224:227], v[56:59]
    ds_read_b64_tr_b16 a[192:193], v204 offset:16384
    v_mfma_f32_16x16x32_bf16 v[60:63], a[52:55], a[224:227], v[60:63]
    ds_read_b64_tr_b16 a[194:195], v204 offset:18432
    s_bfe_u32 s76, s57, 0x40000
    s_lshl_b32 s75, s76, 13
    s_add_u32 s75, s75, s63
    buffer_load_dwordx4 a[0:3], v1, s[28:31], s75 offen offset:0 sc1
    v_mfma_f32_16x16x32_bf16 v[64:67], a[48:51], a[228:231], v[64:67]
    ds_read_b64_tr_b16 a[196:197], v205 offset:16384
    v_mfma_f32_16x16x32_bf16 v[68:71], a[52:55], a[228:231], v[68:71]
    ds_read_b64_tr_b16 a[198:199], v205 offset:18432
    v_mfma_f32_16x16x32_bf16 v[72:75], a[48:51], a[232:235], v[72:75]
    ds_read_b64_tr_b16 a[200:201], v206 offset:16384
    v_mfma_f32_16x16x32_bf16 v[76:79], a[52:55], a[232:235], v[76:79]
    ds_read_b64_tr_b16 a[202:203], v206 offset:18432
    buffer_load_dwordx4 a[4:7], v1, s[28:31], s75 offen offset:1024 sc1
    v_mfma_f32_16x16x32_bf16 v[80:83], a[48:51], a[236:239], v[80:83]
    ds_read_b64_tr_b16 a[204:205], v207 offset:16384
    v_mfma_f32_16x16x32_bf16 v[84:87], a[52:55], a[236:239], v[84:87]
    ds_read_b64_tr_b16 a[206:207], v207 offset:18432
    s_waitcnt vmcnt(10)
    v_mfma_f32_16x16x32_bf16 v[56:59], a[56:59], a[240:243], v[56:59]
    ds_read_b64_tr_b16 a[208:209], v204 offset:20480
    v_mfma_f32_16x16x32_bf16 v[60:63], a[60:63], a[240:243], v[60:63]
    ds_read_b64_tr_b16 a[210:211], v204 offset:22528
    buffer_load_dwordx4 a[8:11], v1, s[28:31], s75 offen offset:2048 sc1
    v_mfma_f32_16x16x32_bf16 v[64:67], a[56:59], a[244:247], v[64:67]
    ds_read_b64_tr_b16 a[212:213], v205 offset:20480
    v_mfma_f32_16x16x32_bf16 v[68:71], a[60:63], a[244:247], v[68:71]
    ds_read_b64_tr_b16 a[214:215], v205 offset:22528
    v_mfma_f32_16x16x32_bf16 v[72:75], a[56:59], a[248:251], v[72:75]
    ds_read_b64_tr_b16 a[216:217], v206 offset:20480
    v_mfma_f32_16x16x32_bf16 v[76:79], a[60:63], a[248:251], v[76:79]
    ds_read_b64_tr_b16 a[218:219], v206 offset:22528
    buffer_load_dwordx4 a[12:15], v1, s[28:31], s75 offen offset:3072 sc1
    v_mfma_f32_16x16x32_bf16 v[80:83], a[56:59], a[252:255], v[80:83]
    ds_read_b64_tr_b16 a[220:221], v207 offset:20480
    v_mfma_f32_16x16x32_bf16 v[84:87], a[60:63], a[252:255], v[84:87]
    ds_read_b64_tr_b16 a[222:223], v207 offset:22528
    s_waitcnt vmcnt(10)
    v_mfma_f32_16x16x32_bf16 v[56:59], a[64:67], v[24:27], v[56:59]
    ds_read_b64_tr_b16 a[224:225], v210 offset:32768
    v_mfma_f32_16x16x32_bf16 v[60:63], a[68:71], v[24:27], v[60:63]
    ds_read_b64_tr_b16 a[226:227], v210 offset:33792
    s_bfe_u32 s76, s57, 0x40004
    s_lshl_b32 s75, s76, 13
    s_add_u32 s75, s75, s63
    buffer_load_dwordx4 a[16:19], v1, s[28:31], s75 offen offset:0 sc1
    v_mfma_f32_16x16x32_bf16 v[64:67], a[64:67], v[28:31], v[64:67]
    ds_read_b64_tr_b16 a[228:229], v211 offset:32768
    v_mfma_f32_16x16x32_bf16 v[68:71], a[68:71], v[28:31], v[68:71]
    ds_read_b64_tr_b16 a[230:231], v211 offset:33792
    v_mfma_f32_16x16x32_bf16 v[72:75], a[64:67], v[32:35], v[72:75]
    ds_read_b64_tr_b16 a[232:233], v210 offset:34816
    v_mfma_f32_16x16x32_bf16 v[76:79], a[68:71], v[32:35], v[76:79]
    ds_read_b64_tr_b16 a[234:235], v210 offset:35840
    buffer_load_dwordx4 a[20:23], v1, s[28:31], s75 offen offset:1024 sc1
    v_mfma_f32_16x16x32_bf16 v[80:83], a[64:67], v[36:39], v[80:83]
    ds_read_b64_tr_b16 a[236:237], v211 offset:34816
    v_mfma_f32_16x16x32_bf16 v[84:87], a[68:71], v[36:39], v[84:87]
    ds_read_b64_tr_b16 a[238:239], v211 offset:35840
    s_waitcnt vmcnt(10)
    v_mfma_f32_16x16x32_bf16 v[56:59], a[72:75], v[40:43], v[56:59]
    ds_read_b64_tr_b16 a[240:241], v210 offset:36864
    v_mfma_f32_16x16x32_bf16 v[60:63], a[76:79], v[40:43], v[60:63]
    ds_read_b64_tr_b16 a[242:243], v210 offset:37888
    buffer_load_dwordx4 a[24:27], v1, s[28:31], s75 offen offset:2048 sc1
    v_mfma_f32_16x16x32_bf16 v[64:67], a[72:75], v[44:47], v[64:67]
    ds_read_b64_tr_b16 a[244:245], v211 offset:36864
    v_mfma_f32_16x16x32_bf16 v[68:71], a[76:79], v[44:47], v[68:71]
    ds_read_b64_tr_b16 a[246:247], v211 offset:37888
    v_mfma_f32_16x16x32_bf16 v[72:75], a[72:75], v[48:51], v[72:75]
    ds_read_b64_tr_b16 a[248:249], v210 offset:38912
    v_mfma_f32_16x16x32_bf16 v[76:79], a[76:79], v[48:51], v[76:79]
    ds_read_b64_tr_b16 a[250:251], v210 offset:39936
    buffer_load_dwordx4 a[28:31], v1, s[28:31], s75 offen offset:3072 sc1
    v_mfma_f32_16x16x32_bf16 v[80:83], a[72:75], v[52:55], v[80:83]
    ds_read_b64_tr_b16 a[252:253], v211 offset:38912
    v_mfma_f32_16x16x32_bf16 v[84:87], a[76:79], v[52:55], v[84:87]
    ds_read_b64_tr_b16 a[254:255], v211 offset:39936
    s_waitcnt vmcnt(10)
    v_mfma_f32_16x16x32_bf16 v[56:59], a[80:83], v[96:99], v[56:59]
    v_mfma_f32_16x16x32_bf16 v[60:63], a[84:87], v[96:99], v[60:63]
    s_bfe_u32 s76, s57, 0x40008
    s_lshl_b32 s75, s76, 13
    s_add_u32 s75, s75, s63
    buffer_load_dwordx4 a[32:35], v1, s[28:31], s75 offen offset:0 sc1
    v_mfma_f32_16x16x32_bf16 v[64:67], a[80:83], v[100:103], v[64:67]
    v_mfma_f32_16x16x32_bf16 v[68:71], a[84:87], v[100:103], v[68:71]
    v_mfma_f32_16x16x32_bf16 v[72:75], a[80:83], v[104:107], v[72:75]
    v_mfma_f32_16x16x32_bf16 v[76:79], a[84:87], v[104:107], v[76:79]
    buffer_load_dwordx4 a[36:39], v1, s[28:31], s75 offen offset:1024 sc1
    v_mfma_f32_16x16x32_bf16 v[80:83], a[80:83], v[108:111], v[80:83]
    v_mfma_f32_16x16x32_bf16 v[84:87], a[84:87], v[108:111], v[84:87]
    s_waitcnt vmcnt(10)
    v_mfma_f32_16x16x32_bf16 v[56:59], a[88:91], v[112:115], v[56:59]
    v_mfma_f32_16x16x32_bf16 v[60:63], a[92:95], v[112:115], v[60:63]
    buffer_load_dwordx4 a[40:43], v1, s[28:31], s75 offen offset:2048 sc1
    v_mfma_f32_16x16x32_bf16 v[64:67], a[88:91], v[116:119], v[64:67]
    v_mfma_f32_16x16x32_bf16 v[68:71], a[92:95], v[116:119], v[68:71]
    v_mfma_f32_16x16x32_bf16 v[72:75], a[88:91], v[120:123], v[72:75]
    v_mfma_f32_16x16x32_bf16 v[76:79], a[92:95], v[120:123], v[76:79]
    buffer_load_dwordx4 a[44:47], v1, s[28:31], s75 offen offset:3072 sc1
    v_mfma_f32_16x16x32_bf16 v[80:83], a[88:91], v[124:127], v[80:83]
    v_mfma_f32_16x16x32_bf16 v[84:87], a[92:95], v[124:127], v[84:87]
    s_waitcnt vmcnt(10)
    v_mfma_f32_16x16x32_bf16 v[56:59], a[0:3], v[148:151], v[56:59]
    v_mfma_f32_16x16x32_bf16 v[60:63], a[4:7], v[148:151], v[60:63]
    s_bfe_u32 s76, s57, 0x4000c
    s_lshl_b32 s75, s76, 13
    s_add_u32 s75, s75, s63
    buffer_load_dwordx4 a[48:51], v1, s[28:31], s75 offen offset:0 sc1
    v_mfma_f32_16x16x32_bf16 v[64:67], a[0:3], v[152:155], v[64:67]
    v_mfma_f32_16x16x32_bf16 v[68:71], a[4:7], v[152:155], v[68:71]
    v_mfma_f32_16x16x32_bf16 v[72:75], a[0:3], v[156:159], v[72:75]
    v_mfma_f32_16x16x32_bf16 v[76:79], a[4:7], v[156:159], v[76:79]
    buffer_load_dwordx4 a[52:55], v1, s[28:31], s75 offen offset:1024 sc1
    v_mfma_f32_16x16x32_bf16 v[80:83], a[0:3], v[160:163], v[80:83]
    v_mfma_f32_16x16x32_bf16 v[84:87], a[4:7], v[160:163], v[84:87]
    s_waitcnt vmcnt(10)
    v_mfma_f32_16x16x32_bf16 v[56:59], a[8:11], v[164:167], v[56:59]
    v_mfma_f32_16x16x32_bf16 v[60:63], a[12:15], v[164:167], v[60:63]
    buffer_load_dwordx4 a[56:59], v1, s[28:31], s75 offen offset:2048 sc1
    v_mfma_f32_16x16x32_bf16 v[64:67], a[8:11], v[168:171], v[64:67]
    v_mfma_f32_16x16x32_bf16 v[68:71], a[12:15], v[168:171], v[68:71]
    v_mfma_f32_16x16x32_bf16 v[72:75], a[8:11], v[172:175], v[72:75]
    v_mfma_f32_16x16x32_bf16 v[76:79], a[12:15], v[172:175], v[76:79]
    buffer_load_dwordx4 a[60:63], v1, s[28:31], s75 offen offset:3072 sc1
    v_mfma_f32_16x16x32_bf16 v[80:83], a[8:11], v[176:179], v[80:83]
    v_mfma_f32_16x16x32_bf16 v[84:87], a[12:15], v[176:179], v[84:87]
    v_min_u32 v19, 7, v0
    v_lshlrev_b32 v19, 7, v19
    s_lshl_b32 s4, s69, 10
    s_add_u32 s81, s4, 10518528
    s_cmp_lg_u32 s3, 1
    s_cbranch_scc1 L_pim9
    buffer_load_dword v252, v19, s[28:31], s81 offen sc1
L_pim9:
    s_waitcnt vmcnt(10)
    v_mfma_f32_16x16x32_bf16 v[56:59], a[16:19], v[220:223], v[56:59]
    ds_read_b64_tr_b16 v[148:149], v210 offset:49152
    v_mfma_f32_16x16x32_bf16 v[60:63], a[20:23], v[220:223], v[60:63]
    ds_read_b64_tr_b16 v[150:151], v210 offset:50176
    s_bfe_u32 s76, s57, 0x40010
    s_lshl_b32 s75, s76, 13
    s_add_u32 s75, s75, s63
    buffer_load_dwordx4 a[64:67], v1, s[28:31], s75 offen offset:0 sc1
    v_mfma_f32_16x16x32_bf16 v[64:67], a[16:19], v[224:227], v[64:67]
    ds_read_b64_tr_b16 v[152:153], v211 offset:49152
    v_mfma_f32_16x16x32_bf16 v[68:71], a[20:23], v[224:227], v[68:71]
    ds_read_b64_tr_b16 v[154:155], v211 offset:50176
    v_mfma_f32_16x16x32_bf16 v[72:75], a[16:19], v[228:231], v[72:75]
    ds_read_b64_tr_b16 v[156:157], v210 offset:51200
    v_mfma_f32_16x16x32_bf16 v[76:79], a[20:23], v[228:231], v[76:79]
    ds_read_b64_tr_b16 v[158:159], v210 offset:52224
    buffer_load_dwordx4 a[68:71], v1, s[28:31], s75 offen offset:1024 sc1
    v_mfma_f32_16x16x32_bf16 v[80:83], a[16:19], v[232:235], v[80:83]
    ds_read_b64_tr_b16 v[160:161], v211 offset:51200
    v_mfma_f32_16x16x32_bf16 v[84:87], a[20:23], v[232:235], v[84:87]
    ds_read_b64_tr_b16 v[162:163], v211 offset:52224
    s_waitcnt vmcnt(10)
    v_mfma_f32_16x16x32_bf16 v[56:59], a[24:27], v[236:239], v[56:59]
    ds_read_b64_tr_b16 v[164:165], v210 offset:53248
    v_mfma_f32_16x16x32_bf16 v[60:63], a[28:31], v[236:239], v[60:63]
    ds_read_b64_tr_b16 v[166:167], v210 offset:54272
    buffer_load_dwordx4 a[72:75], v1, s[28:31], s75 offen offset:2048 sc1
    v_mfma_f32_16x16x32_bf16 v[64:67], a[24:27], v[240:243], v[64:67]
    ds_read_b64_tr_b16 v[168:169], v211 offset:53248
    v_mfma_f32_16x16x32_bf16 v[68:71], a[28:31], v[240:243], v[68:71]
    ds_read_b64_tr_b16 v[170:171], v211 offset:54272
    v_mfma_f32_16x16x32_bf16 v[72:75], a[24:27], v[244:247], v[72:75]
    ds_read_b64_tr_b16 v[172:173], v210 offset:55296
    v_mfma_f32_16x16x32_bf16 v[76:79], a[28:31], v[244:247], v[76:79]
    ds_read_b64_tr_b16 v[174:175], v210 offset:56320
    buffer_load_dwordx4 a[76:79], v1, s[28:31], s75 offen offset:3072 sc1
    v_mfma_f32_16x16x32_bf16 v[80:83], a[24:27], v[248:251], v[80:83]
    ds_read_b64_tr_b16 v[176:177], v211 offset:55296
    v_mfma_f32_16x16x32_bf16 v[84:87], a[28:31], v[248:251], v[84:87]
    ds_read_b64_tr_b16 v[178:179], v211 offset:56320
    s_waitcnt vmcnt(10)
    s_waitcnt lgkmcnt(15)
    v_mfma_f32_16x16x32_bf16 v[56:59], a[32:35], a[96:99], v[56:59]
    ds_read_b64_tr_b16 v[220:221], v208 offset:0
    v_mfma_f32_16x16x32_bf16 v[60:63], a[36:39], a[96:99], v[60:63]
    ds_read_b64_tr_b16 v[222:223], v208 offset:1024
    s_bfe_u32 s76, s57, 0x40014
    s_lshl_b32 s75, s76, 13
    s_add_u32 s75, s75, s63
    buffer_load_dwordx4 a[80:83], v1, s[28:31], s75 offen offset:0 sc1
    v_mfma_f32_16x16x32_bf16 v[64:67], a[32:35], a[100:103], v[64:67]
    ds_read_b64_tr_b16 v[224:225], v209 offset:0
    v_mfma_f32_16x16x32_bf16 v[68:71], a[36:39], a[100:103], v[68:71]
    ds_read_b64_tr_b16 v[226:227], v209 offset:1024
    v_mfma_f32_16x16x32_bf16 v[72:75], a[32:35], a[104:107], v[72:75]
    ds_read_b64_tr_b16 v[228:229], v208 offset:2048
    v_mfma_f32_16x16x32_bf16 v[76:79], a[36:39], a[104:107], v[76:79]
    ds_read_b64_tr_b16 v[230:231], v208 offset:3072
    buffer_load_dwordx4 a[84:87], v1, s[28:31], s75 offen offset:1024 sc1
    v_mfma_f32_16x16x32_bf16 v[80:83], a[32:35], a[108:111], v[80:83]
    ds_read_b64_tr_b16 v[232:233], v209 offset:2048
    v_mfma_f32_16x16x32_bf16 v[84:87], a[36:39], a[108:111], v[84:87]
    ds_read_b64_tr_b16 v[234:235], v209 offset:3072
    s_waitcnt vmcnt(10)
    v_mfma_f32_16x16x32_bf16 v[56:59], a[40:43], a[112:115], v[56:59]
    ds_read_b64_tr_b16 v[236:237], v208 offset:4096
    v_mfma_f32_16x16x32_bf16 v[60:63], a[44:47], a[112:115], v[60:63]
    ds_read_b64_tr_b16 v[238:239], v208 offset:5120
    buffer_load_dwordx4 a[88:91], v1, s[28:31], s75 offen offset:2048 sc1
    v_mfma_f32_16x16x32_bf16 v[64:67], a[40:43], a[116:119], v[64:67]
    ds_read_b64_tr_b16 v[240:241], v209 offset:4096
    v_mfma_f32_16x16x32_bf16 v[68:71], a[44:47], a[116:119], v[68:71]
    ds_read_b64_tr_b16 v[242:243], v209 offset:5120
    v_mfma_f32_16x16x32_bf16 v[72:75], a[40:43], a[120:123], v[72:75]
    ds_read_b64_tr_b16 v[244:245], v208 offset:6144
    v_mfma_f32_16x16x32_bf16 v[76:79], a[44:47], a[120:123], v[76:79]
    ds_read_b64_tr_b16 v[246:247], v208 offset:7168
    buffer_load_dwordx4 a[92:95], v1, s[28:31], s75 offen offset:3072 sc1
    v_mfma_f32_16x16x32_bf16 v[80:83], a[40:43], a[124:127], v[80:83]
    ds_read_b64_tr_b16 v[248:249], v209 offset:6144
    v_mfma_f32_16x16x32_bf16 v[84:87], a[44:47], a[124:127], v[84:87]
    ds_read_b64_tr_b16 v[250:251], v209 offset:7168
    s_waitcnt lgkmcnt(15)
    s_cmp_lg_u32 s3, 1
    s_cbranch_scc1 L_okm10
    s_waitcnt vmcnt(8)
    v_cmp_ne_u32 vcc, s64, v252
    s_cbranch_vccz L_okm10
    s_mov_b32 s79, 100000
L_okm10s:
    buffer_load_dword v252, v19, s[28:31], s81 offen sc1
    s_waitcnt vmcnt(0)
    v_cmp_ne_u32 vcc, s64, v252
    s_cbranch_vccz L_okm10
    s_sub_u32 s79, s79, 1
    s_cmp_lg_u32 s79, 0
    s_cbranch_scc1 L_okm10s
L_okm10:
    s_barrier
    s_waitcnt vmcnt(10)
    v_mfma_f32_16x16x32_bf16 v[56:59], a[48:51], a[128:131], v[56:59]
    ds_read_b64_tr_b16 a[96:97], v208 offset:16384
    v_mfma_f32_16x16x32_bf16 v[60:63], a[52:55], a[128:131], v[60:63]
    ds_read_b64_tr_b16 a[98:99], v208 offset:17408
    s_bfe_u32 s76, s54, 0x40000
    s_lshl_b32 s75, s76, 13
    s_add_u32 s75, s75, s62
    buffer_load_dwordx4 a[0:3], v1, s[28:31], s75 offen offset:0 sc1
    v_mfma_f32_16x16x32_bf16 v[64:67], a[48:51], a[132:135], v[64:67]
    ds_read_b64_tr_b16 a[100:101], v209 offset:16384
    v_mfma_f32_16x16x32_bf16 v[68:71], a[52:55], a[132:135], v[68:71]
    ds_read_b64_tr_b16 a[102:103], v209 offset:17408
    v_mfma_f32_16x16x32_bf16 v[72:75], a[48:51], a[136:139], v[72:75]
    ds_read_b64_tr_b16 a[104:105], v208 offset:18432
    v_mfma_f32_16x16x32_bf16 v[76:79], a[52:55], a[136:139], v[76:79]
    ds_read_b64_tr_b16 a[106:107], v208 offset:19456
    buffer_load_dwordx4 a[4:7], v1, s[28:31], s75 offen offset:1024 sc1
    v_mfma_f32_16x16x32_bf16 v[80:83], a[48:51], a[140:143], v[80:83]
    ds_read_b64_tr_b16 a[108:109], v209 offset:18432
    v_mfma_f32_16x16x32_bf16 v[84:87], a[52:55], a[140:143], v[84:87]
    ds_read_b64_tr_b16 a[110:111], v209 offset:19456
    s_waitcnt vmcnt(10)
    v_mfma_f32_16x16x32_bf16 v[56:59], a[56:59], a[144:147], v[56:59]
    ds_read_b64_tr_b16 a[112:113], v208 offset:20480
    v_mfma_f32_16x16x32_bf16 v[60:63], a[60:63], a[144:147], v[60:63]
    ds_read_b64_tr_b16 a[114:115], v208 offset:21504
    buffer_load_dwordx4 a[8:11], v1, s[28:31], s75 offen offset:2048 sc1
    v_mfma_f32_16x16x32_bf16 v[64:67], a[56:59], a[148:151], v[64:67]
    ds_read_b64_tr_b16 a[116:117], v209 offset:20480
    v_mfma_f32_16x16x32_bf16 v[68:71], a[60:63], a[148:151], v[68:71]
    ds_read_b64_tr_b16 a[118:119], v209 offset:21504
    v_mfma_f32_16x16x32_bf16 v[72:75], a[56:59], a[152:155], v[72:75]
    ds_read_b64_tr_b16 a[120:121], v208 offset:22528
    v_mfma_f32_16x16x32_bf16 v[76:79], a[60:63], a[152:155], v[76:79]
    ds_read_b64_tr_b16 a[122:123], v208 offset:23552
    buffer_load_dwordx4 a[12:15], v1, s[28:31], s75 offen offset:3072 sc1
    v_mfma_f32_16x16x32_bf16 v[80:83], a[56:59], a[156:159], v[80:83]
    ds_read_b64_tr_b16 a[124:125], v209 offset:22528
    v_mfma_f32_16x16x32_bf16 v[84:87], a[60:63], a[156:159], v[84:87]
    ds_read_b64_tr_b16 a[126:127], v209 offset:23552
    s_waitcnt vmcnt(10)
    v_mfma_f32_16x16x32_bf16 v[56:59], a[64:67], a[160:163], v[56:59]
    v_mfma_f32_16x16x32_bf16 v[60:63], a[68:71], a[160:163], v[60:63]
    s_bfe_u32 s76, s54, 0x40004
    s_lshl_b32 s75, s76, 13
    s_add_u32 s75, s75, s62
    buffer_load_dwordx4 a[16:19], v1, s[28:31], s75 offen offset:0 sc1
    v_mfma_f32_16x16x32_bf16 v[64:67], a[64:67], a[164:167], v[64:67]
    v_mfma_f32_16x16x32_bf16 v[68:71], a[68:71], a[164:167], v[68:71]
    v_mfma_f32_16x16x32_bf16 v[72:75], a[64:67], a[168:171], v[72:75]
    v_mfma_f32_16x16x32_bf16 v[76:79], a[68:71], a[168:171], v[76:79]
    buffer_load_dwordx4 a[20:23], v1, s[28:31], s75 offen offset:1024 sc1
    v_mfma_f32_16x16x32_bf16 v[80:83], a[64:67], a[172:175], v[80:83]
    v_mfma_f32_16x16x32_bf16 v[84:87], a[68:71], a[172:175], v[84:87]
    s_waitcnt vmcnt(10)
    v_mfma_f32_16x16x32_bf16 v[56:59], a[72:75], a[176:179], v[56:59]
    v_mfma_f32_16x16x32_bf16 v[60:63], a[76:79], a[176:179], v[60:63]
    buffer_load_dwordx4 a[24:27], v1, s[28:31], s75 offen offset:2048 sc1
    v_mfma_f32_16x16x32_bf16 v[64:67], a[72:75], a[180:183], v[64:67]
    v_mfma_f32_16x16x32_bf16 v[68:71], a[76:79], a[180:183], v[68:71]
    v_mfma_f32_16x16x32_bf16 v[72:75], a[72:75], a[184:187], v[72:75]
    v_mfma_f32_16x16x32_bf16 v[76:79], a[76:79], a[184:187], v[76:79]
    buffer_load_dwordx4 a[28:31], v1, s[28:31], s75 offen offset:3072 sc1
    v_mfma_f32_16x16x32_bf16 v[80:83], a[72:75], a[188:191], v[80:83]
    v_mfma_f32_16x16x32_bf16 v[84:87], a[76:79], a[188:191], v[84:87]
    v_xor_b32 v217, 4096, v216
    s_waitcnt vmcnt(10)
    v_mfma_f32_16x16x32_bf16 v[72:75], a[80:83], a[200:203], v[72:75]
    v_mfma_f32_16x16x32_bf16 v[76:79], a[84:87], a[200:203], v[76:79]
    s_bfe_u32 s76, s54, 0x40008
    s_lshl_b32 s75, s76, 13
    s_add_u32 s75, s75, s62
    buffer_load_dwordx4 a[32:35], v1, s[28:31], s75 offen offset:0 sc1
    v_mfma_f32_16x16x32_bf16 v[80:83], a[80:83], a[204:207], v[80:83]
    v_mfma_f32_16x16x32_bf16 v[84:87], a[84:87], a[204:207], v[84:87]
    buffer_load_dwordx4 a[36:39], v1, s[28:31], s75 offen offset:1024 sc1
    s_waitcnt vmcnt(10)
    v_mfma_f32_16x16x32_bf16 v[72:75], a[88:91], a[216:219], v[72:75]
    v_mfma_f32_16x16x32_bf16 v[76:79], a[92:95], a[216:219], v[76:79]
    buffer_load_dwordx4 a[40:43], v1, s[28:31], s75 offen offset:2048 sc1
    v_mfma_f32_16x16x32_bf16 v[80:83], a[88:91], a[220:223], v[80:83]
    v_mfma_f32_16x16x32_bf16 v[84:87], a[92:95], a[220:223], v[84:87]
    v_mfma_f32_16x16x32_bf16 v[56:59], a[80:83], a[192:195], v[56:59]
    v_mfma_f32_16x16x32_bf16 v[60:63], a[84:87], a[192:195], v[60:63]
    buffer_load_dwordx4 a[44:47], v1, s[28:31], s75 offen offset:3072 sc1
    v_mfma_f32_16x16x32_bf16 v[64:67], a[80:83], a[196:199], v[64:67]
    v_mfma_f32_16x16x32_bf16 v[68:71], a[84:87], a[196:199], v[68:71]
    ds_write_b128 v216, v[72:75] offset:0
    v_mfma_f32_16x16x32_bf16 v[56:59], a[88:91], a[208:211], v[56:59]
    v_mfma_f32_16x16x32_bf16 v[60:63], a[92:95], a[208:211], v[60:63]
    ds_write_b128 v216, v[76:79] offset:1024
    ds_write_b128 v216, v[80:83] offset:2048
    s_bfe_u32 s76, s54, 0x4000c
    s_lshl_b32 s75, s76, 13
    s_add_u32 s75, s75, s62
    buffer_load_dwordx4 a[48:51], v1, s[28:31], s75 offen offset:0 sc1
    v_mfma_f32_16x16x32_bf16 v[64:67], a[88:91], a[212:215], v[64:67]
    v_mfma_f32_16x16x32_bf16 v[68:71], a[92:95], a[212:215], v[68:71]
    ds_write_b128 v216, v[84:87] offset:3072
    s_waitcnt lgkmcnt(4)
    s_waitcnt lgkmcnt(0)
    s_barrier
    s_waitcnt vmcnt(11)
    v_mfma_f32_32x32x16_bf16 v[24:39], a[224:227], a[0:3], 0
    ds_read_b128 v[72:75], v217 offset:0
    ds_read_b128 v[80:83], v217 offset:2048
    ds_read_b128 v[76:79], v217 offset:1024
    ds_read_b128 v[84:87], v217 offset:3072
    buffer_load_dwordx4 a[52:55], v1, s[28:31], s75 offen offset:1024 sc1
    v_mfma_f32_32x32x16_bf16 v[40:55], a[228:231], a[0:3], 0
    v_mfma_f32_32x32x16_bf16 v[24:39], a[232:235], a[4:7], v[24:39]
    s_waitcnt lgkmcnt(3)
    v_add_f32 v56, v56, v72
    v_mul_f32 v96, 0xbfb8aa3b, v56
    s_waitcnt lgkmcnt(2)
    v_add_f32 v64, v64, v80
    v_exp_f32 v96, v96
    v_mul_f32 v104, 0xbfb8aa3b, v64
    buffer_load_dwordx4 a[56:59], v1, s[28:31], s75 offen offset:2048 sc1
    v_mfma_f32_32x32x16_bf16 v[40:55], a[236:239], a[4:7], v[40:55]
    v_add_f32 v57, v57, v73
    v_add_f32 v96, 1.0, v96
    v_exp_f32 v104, v104
    v_mul_f32 v97, 0xbfb8aa3b, v57
    v_add_f32 v65, v65, v81
    s_waitcnt vmcnt(11)
    v_mfma_f32_32x32x16_bf16 v[24:39], a[240:243], a[8:11], v[24:39]
    v_rcp_f32 v96, v96
    v_add_f32 v104, 1.0, v104
    v_exp_f32 v97, v97
    v_mul_f32 v105, 0xbfb8aa3b, v65
    buffer_load_dwordx4 a[60:63], v1, s[28:31], s75 offen offset:3072 sc1
    v_mfma_f32_32x32x16_bf16 v[40:55], a[244:247], a[8:11], v[40:55]
    v_add_f32 v58, v58, v74
    v_mul_f32 v56, v56, v96
    v_rcp_f32 v104, v104
    v_add_f32 v97, 1.0, v97
    v_mfma_f32_32x32x16_bf16 v[24:39], a[248:251], a[12:15], v[24:39]
    v_exp_f32 v105, v105
    v_mul_f32 v98, 0xbfb8aa3b, v58
    v_add_f32 v66, v66, v82
    v_mul_f32 v64, v64, v104
    v_mfma_f32_32x32x16_bf16 v[40:55], a[252:255], a[12:15], v[40:55]
    v_rcp_f32 v97, v97
    v_add_f32 v105, 1.0, v105
    v_exp_f32 v98, v98
    v_mul_f32 v106, 0xbfb8aa3b, v66
    v_subrev_u32 v216, 114688, v216
    v_xor_b32 v217, 8192, v216
    s_waitcnt vmcnt(10)
    v_mfma_f32_32x32x16_bf16 v[40:55], v[152:155], a[16:19], v[40:55]
    v_add_f32 v59, v59, v75
    v_mul_f32 v57, v57, v97
    v_rcp_f32 v105, v105
    v_add_f32 v98, 1.0, v98
    v_mfma_f32_32x32x16_bf16 v[40:55], v[160:163], a[20:23], v[40:55]
    v_exp_f32 v106, v106
    v_mul_f32 v99, 0xbfb8aa3b, v59
    v_add_f32 v67, v67, v83
    v_permlane16_swap_b32 v56, v64
    v_mul_f32 v65, v65, v105
    s_waitcnt vmcnt(8)
    v_mfma_f32_32x32x16_bf16 v[40:55], v[168:171], a[24:27], v[40:55]
    v_rcp_f32 v98, v98
    v_add_f32 v106, 1.0, v106
    v_exp_f32 v99, v99
    v_mul_f32 v107, 0xbfb8aa3b, v67
    v_mfma_f32_32x32x16_bf16 v[40:55], v[176:179], a[28:31], v[40:55]
    s_waitcnt lgkmcnt(1)
    v_add_f32 v60, v60, v76
    v_mul_f32 v58, v58, v98
    v_rcp_f32 v106, v106
    v_add_f32 v99, 1.0, v99
    s_waitcnt vmcnt(6)
    v_mfma_f32_32x32x16_bf16 v[40:55], v[224:227], a[32:35], v[40:55]
    v_exp_f32 v107, v107
    v_mul_f32 v100, 0xbfb8aa3b, v60
L_w6:
    s_cbranch_execz L_wret
    s_waitcnt lgkmcnt(0)
    v_add_f32 v68, v68, v84
    v_permlane16_swap_b32 v57, v65
    v_mul_f32 v66, v66, v106
    v_mfma_f32_32x32x16_bf16 v[40:55], v[232:235], a[36:39], v[40:55]
    v_rcp_f32 v99, v99
    v_add_f32 v107, 1.0, v107
    v_exp_f32 v100, v100
    v_mul_f32 v108, 0xbfb8aa3b, v68
    s_waitcnt vmcnt(4)
    v_mfma_f32_32x32x16_bf16 v[40:55], v[240:243], a[40:43], v[40:55]
    v_add_f32 v61, v61, v77
    v_mul_f32 v59, v59, v99
    v_rcp_f32 v107, v107
    v_add_f32 v100, 1.0, v100
    v_mfma_f32_32x32x16_bf16 v[40:55], v[248:251], a[44:47], v[40:55]
    v_exp_f32 v108, v108
    v_mul_f32 v101, 0xbfb8aa3b, v61
    v_add_f32 v69, v69, v85
    v_permlane16_swap_b32 v58, v66
    v_mul_f32 v67, v67, v107
    s_waitcnt vmcnt(2)
    v_mfma_f32_32x32x16_bf16 v[40:55], a[100:103], a[48:51], v[40:55]
    v_rcp_f32 v100, v100
    v_add_f32 v108, 1.0, v108
    v_exp_f32 v101, v101
    v_mul_f32 v109, 0xbfb8aa3b, v69
    v_mfma_f32_32x32x16_bf16 v[40:55], a[108:111], a[52:55], v[40:55]
    v_add_f32 v62, v62, v78
    v_mul_f32 v60, v60, v100
    v_rcp_f32 v108, v108
    v_add_f32 v101, 1.0, v101
    s_waitcnt vmcnt(0)
    v_mfma_f32_32x32x16_bf16 v[40:55], a[116:119], a[56:59], v[40:55]
    v_exp_f32 v109, v109
    v_mul_f32 v102, 0xbfb8aa3b, v62
    v_add_f32 v70, v70, v86
    v_permlane16_swap_b32 v59, v67
    v_mul_f32 v68, v68, v108
    v_mfma_f32_32x32x16_bf16 v[40:55], a[124:127], a[60:63], v[40:55]
    v_rcp_f32 v101, v101
    v_add_f32 v109, 1.0, v109
    v_exp_f32 v102, v102
    v_mul_f32 v110, 0xbfb8aa3b, v70
    v_mfma_f32_32x32x16_bf16 v[24:39], v[148:151], a[16:19], v[24:39]
    v_add_f32 v63, v63, v79
    v_mul_f32 v61, v61, v101
    v_rcp_f32 v109, v109
    v_add_f32 v102, 1.0, v102
    v_mfma_f32_32x32x16_bf16 v[24:39], v[156:159], a[20:23], v[24:39]
    s_nop 1
    ds_write_b128 v216, v[40:43] offset:0
    v_mfma_f32_32x32x16_bf16 v[24:39], v[164:167], a[24:27], v[24:39]
    v_exp_f32 v110, v110
    v_mul_f32 v103, 0xbfb8aa3b, v63
    v_add_f32 v71, v71, v87
    v_permlane16_swap_b32 v60, v68
    v_mul_f32 v69, v69, v109
    v_mfma_f32_32x32x16_bf16 v[24:39], v[172:175], a[28:31], v[24:39]
    ds_write_b128 v216, v[44:47] offset:1024
    v_mfma_f32_32x32x16_bf16 v[24:39], v[220:223], a[32:35], v[24:39]
    v_rcp_f32 v102, v102
    v_add_f32 v110, 1.0, v110
    v_exp_f32 v103, v103
    v_mul_f32 v111, 0xbfb8aa3b, v71
    v_mfma_f32_32x32x16_bf16 v[24:39], v[228:231], a[36:39], v[24:39]
    ds_write_b128 v216, v[48:51] offset:2048
    v_mfma_f32_32x32x16_bf16 v[24:39], v[236:239], a[40:43], v[24:39]
    v_mul_f32 v62, v62, v102
    v_rcp_f32 v110, v110
    v_add_f32 v103, 1.0, v103
    v_exp_f32 v111, v111
    v_mfma_f32_32x32x16_bf16 v[24:39], v[244:247], a[44:47], v[24:39]
    ds_write_b128 v216, v[52:55] offset:3072
    v_mfma_f32_32x32x16_bf16 v[24:39], a[96:99], a[48:51], v[24:39]
    v_permlane16_swap_b32 v61, v69
    v_mul_f32 v70, v70, v110
    v_rcp_f32 v103, v103
    v_add_f32 v111, 1.0, v111
    v_mul_f32 v63, v63, v103
    v_mfma_f32_32x32x16_bf16 v[24:39], a[104:107], a[52:55], v[24:39]
    s_waitcnt lgkmcnt(0)
    s_barrier
    ds_read_b128 v[40:43], v217 offset:0
    ds_read_b128 v[44:47], v217 offset:1024
    ds_read_b128 v[48:51], v217 offset:2048
    ds_read_b128 v[52:55], v217 offset:3072
    v_mfma_f32_32x32x16_bf16 v[24:39], a[112:115], a[56:59], v[24:39]
    v_rcp_f32 v111, v111
    v_permlane16_swap_b32 v62, v70
    v_mul_f32 v71, v71, v111
    s_nop 1
    v_permlane16_swap_b32 v63, v71
    v_mfma_f32_32x32x16_bf16 v[24:39], a[120:123], a[60:63], v[24:39]
    s_waitcnt lgkmcnt(0)
    v_pk_fma_f32 v[128:129], v[40:41], v[56:57], v[128:129]
    v_pk_fma_f32 v[130:131], v[42:43], v[58:59], v[130:131]
    v_pk_fma_f32 v[132:133], v[44:45], v[64:65], v[132:133]
    v_pk_fma_f32 v[134:135], v[46:47], v[66:67], v[134:135]
    v_pk_fma_f32 v[136:137], v[48:49], v[60:61], v[136:137]
    v_pk_fma_f32 v[138:139], v[50:51], v[62:63], v[138:139]
    v_pk_fma_f32 v[140:141], v[52:53], v[68:69], v[140:141]
    v_pk_fma_f32 v[142:143], v[54:55], v[70:71], v[142:143]
    s_nop 2
    v_pk_fma_f32 v[128:129], v[24:25], v[56:57], v[128:129]
    v_pk_fma_f32 v[130:131], v[26:27], v[58:59], v[130:131]
    v_cvt_pk_bf16_f32 v88, v128, v129
    v_cvt_pk_bf16_f32 v89, v130, v131
    ds_write_b64 v218, v[88:89] offset:0
    v_pk_fma_f32 v[132:133], v[28:29], v[64:65], v[132:133]
    v_pk_fma_f32 v[134:135], v[30:31], v[66:67], v[134:135]
    v_cvt_pk_bf16_f32 v90, v132, v133
    v_cvt_pk_bf16_f32 v91, v134, v135
    ds_write_b64 v218, v[90:91] offset:8
    v_pk_fma_f32 v[136:137], v[32:33], v[60:61], v[136:137]
    v_pk_fma_f32 v[138:139], v[34:35], v[62:63], v[138:139]
    v_cvt_pk_bf16_f32 v92, v136, v137
    v_cvt_pk_bf16_f32 v93, v138, v139
    ds_write_b64 v17, v[92:93] offset:0
    v_pk_fma_f32 v[140:141], v[36:37], v[68:69], v[140:141]
    v_pk_fma_f32 v[142:143], v[38:39], v[70:71], v[142:143]
    v_cvt_pk_bf16_f32 v94, v140, v141
    v_cvt_pk_bf16_f32 v95, v142, v143
    ds_write_b64 v17, v[94:95] offset:8
    s_waitcnt lgkmcnt(0)
    s_barrier
    ds_read_b128 v[96:99], v18 offset:0
    ds_read_b128 v[100:103], v18 offset:1024
    s_waitcnt lgkmcnt(1)
    buffer_store_dwordx4 v[96:99], v4, s[32:35], s50 offen offset:0 sc1
    s_waitcnt lgkmcnt(0)
    buffer_store_dwordx4 v[100:103], v5, s[32:35], s50 offen offset:1024 sc1
    s_endpgm
L_helper:
    v_lshrrev_b32 v16, 3, v0
    v_and_b32 v220, 7, v0
    v_lshlrev_b32 v220, 7, v220
    v_lshl_add_u32 v220, v16, 12, v220
    s_and_b32 s4, s65, 1
    s_mul_i32 s4, s4, 768
    s_add_u32 s4, s4, 256
    s_and_b32 s5, s66, 3
    s_lshl_b32 s5, s5, 2
    s_add_u32 s5, s5, s3
    s_lshl_b32 s5, s5, 3
    s_add_u32 s4, s4, s5
    s_lshl_b32 s4, s4, 12
    s_lshr_b32 s5, s65, 1
    s_lshl_b32 s5, s5, 10
    s_add_u32 s84, s4, s5
    s_waitcnt vmcnt(16)
    s_waitcnt lgkmcnt(0)
    s_barrier
    v_and_b32 v16, 31, v0
    v_lshlrev_b32 v16, 1, v16
    s_lshl_b32 s4, s48, 6
    buffer_load_ushort v254, v16, s[40:43], s4 offen
    buffer_load_dword v221, v220, s[24:27], s84 offen
    s_add_u32 s84, s84, 524288
    v_mfma_f32_16x16x32_bf16 v[84:87], v[144:147], v[144:147], v[84:87]
    ds_read_b64_tr_b16 v[116:117], v14 offset:32768
    v_smfmac_f32_16x16x64_bf16 v[88:91], v[80:83], v[144:151], v72
    ds_read_b64_tr_b16 v[118:119], v14 offset:33280
    v_smfmac_f32_16x16x64_bf16 v[76:79], v[80:83], v[152:159], v72
    ds_read_b64_tr_b16 v[120:121], v14 offset:40960
    v_mfma_f32_16x16x32_bf16 v[24:27], v[148:151], v[128:131], v[24:27]
    ds_read_b64_tr_b16 v[122:123], v14 offset:41472
    v_mfma_f32_16x16x32_bf16 v[28:31], v[148:151], v[132:135], v[28:31]
    ds_read_b64_tr_b16 v[124:125], v14 offset:49152
    v_mfma_f32_16x16x32_bf16 v[32:35], v[148:151], v[136:139], v[32:35]
    ds_read_b64_tr_b16 v[126:127], v14 offset:49664
    v_mfma_f32_16x16x32_bf16 v[36:39], v[148:151], v[140:143], v[36:39]
    ds_read_b128 v[96:99], v6 offset:32768
    v_mfma_f32_16x16x32_bf16 v[40:43], v[128:131], v[152:155], v[40:43]
    ds_read_b128 v[100:103], v6 offset:34816
    v_mfma_f32_16x16x32_bf16 v[56:59], v[128:131], v[156:159], v[56:59]
    ds_read_b128 v[104:107], v6 offset:36864
    v_mfma_f32_16x16x32_bf16 v[60:63], v[132:135], v[156:159], v[60:63]
    ds_read_b128 v[108:111], v6 offset:38912
    v_mfma_f32_16x16x32_bf16 v[44:47], v[132:135], v[152:155], v[44:47]
    ds_read_b128 v[112:115], v10 offset:32768
    v_mfma_f32_16x16x32_bf16 v[48:51], v[136:139], v[152:155], v[48:51]
    v_mfma_f32_16x16x32_bf16 v[64:67], v[136:139], v[156:159], v[64:67]
    v_mfma_f32_16x16x32_bf16 v[68:71], v[140:143], v[156:159], v[68:71]
    v_mfma_f32_16x16x32_bf16 v[52:55], v[140:143], v[152:155], v[52:55]
    s_waitcnt lgkmcnt(0)
    v_mfma_f32_16x16x32_bf16 v[84:87], v[112:115], v[112:115], v[84:87]
    ds_read_b64_tr_b16 v[148:149], v14 offset:36864
    v_smfmac_f32_16x16x64_bf16 v[88:91], v[80:83], v[112:119], v72
    ds_read_b64_tr_b16 v[150:151], v14 offset:37376
    v_smfmac_f32_16x16x64_bf16 v[76:79], v[80:83], v[120:127], v72
    ds_read_b64_tr_b16 v[152:153], v14 offset:45056
    v_mfma_f32_16x16x32_bf16 v[24:27], v[116:119], v[96:99], v[24:27]
    ds_read_b64_tr_b16 v[154:155], v14 offset:45568
    v_mfma_f32_16x16x32_bf16 v[28:31], v[116:119], v[100:103], v[28:31]
    ds_read_b64_tr_b16 v[156:157], v14 offset:53248
    v_mfma_f32_16x16x32_bf16 v[32:35], v[116:119], v[104:107], v[32:35]
    ds_read_b64_tr_b16 v[158:159], v14 offset:53760
    v_mfma_f32_16x16x32_bf16 v[36:39], v[116:119], v[108:111], v[36:39]
    ds_read_b128 v[128:131], v7 offset:32768
    v_mfma_f32_16x16x32_bf16 v[40:43], v[96:99], v[120:123], v[40:43]
    ds_read_b128 v[132:135], v7 offset:34816
    v_mfma_f32_16x16x32_bf16 v[56:59], v[96:99], v[124:127], v[56:59]
    ds_read_b128 v[136:139], v7 offset:36864
    v_mfma_f32_16x16x32_bf16 v[60:63], v[100:103], v[124:127], v[60:63]
    ds_read_b128 v[140:143], v7 offset:38912
    v_mfma_f32_16x16x32_bf16 v[44:47], v[100:103], v[120:123], v[44:47]
    ds_read_b128 v[144:147], v11 offset:32768
    v_mfma_f32_16x16x32_bf16 v[48:51], v[104:107], v[120:123], v[48:51]
    v_mfma_f32_16x16x32_bf16 v[64:67], v[104:107], v[124:127], v[64:67]
    v_mfma_f32_16x16x32_bf16 v[68:71], v[108:111], v[124:127], v[68:71]
    v_mfma_f32_16x16x32_bf16 v[52:55], v[108:111], v[120:123], v[52:55]
    s_waitcnt vmcnt(10)
    s_waitcnt lgkmcnt(0)
    s_barrier
    v_mfma_f32_16x16x32_bf16 v[84:87], v[144:147], v[144:147], v[84:87]
    ds_read_b64_tr_b16 v[116:117], v15 offset:0
    v_smfmac_f32_16x16x64_bf16 v[88:91], v[80:83], v[144:151], v72
    ds_read_b64_tr_b16 v[118:119], v15 offset:512
    v_smfmac_f32_16x16x64_bf16 v[76:79], v[80:83], v[152:159], v72
    ds_read_b64_tr_b16 v[120:121], v15 offset:8192
    v_mfma_f32_16x16x32_bf16 v[24:27], v[148:151], v[128:131], v[24:27]
    ds_read_b64_tr_b16 v[122:123], v15 offset:8704
    v_mfma_f32_16x16x32_bf16 v[28:31], v[148:151], v[132:135], v[28:31]
    ds_read_b64_tr_b16 v[124:125], v15 offset:16384
    v_mfma_f32_16x16x32_bf16 v[32:35], v[148:151], v[136:139], v[32:35]
    ds_read_b64_tr_b16 v[126:127], v15 offset:16896
    v_mfma_f32_16x16x32_bf16 v[36:39], v[148:151], v[140:143], v[36:39]
    ds_read_b128 v[96:99], v8 offset:0
    v_mfma_f32_16x16x32_bf16 v[40:43], v[128:131], v[152:155], v[40:43]
    ds_read_b128 v[100:103], v8 offset:2048
    v_mfma_f32_16x16x32_bf16 v[56:59], v[128:131], v[156:159], v[56:59]
    ds_read_b128 v[104:107], v8 offset:4096
    v_mfma_f32_16x16x32_bf16 v[60:63], v[132:135], v[156:159], v[60:63]
    ds_read_b128 v[108:111], v8 offset:6144
    v_mfma_f32_16x16x32_bf16 v[44:47], v[132:135], v[152:155], v[44:47]
    ds_read_b128 v[112:115], v12 offset:0
    v_mfma_f32_16x16x32_bf16 v[48:51], v[136:139], v[152:155], v[48:51]
    v_mfma_f32_16x16x32_bf16 v[64:67], v[136:139], v[156:159], v[64:67]
    v_mfma_f32_16x16x32_bf16 v[68:71], v[140:143], v[156:159], v[68:71]
    v_mfma_f32_16x16x32_bf16 v[52:55], v[140:143], v[152:155], v[52:55]
    s_waitcnt lgkmcnt(0)
    v_mfma_f32_16x16x32_bf16 v[84:87], v[112:115], v[112:115], v[84:87]
    ds_read_b64_tr_b16 v[148:149], v15 offset:4096
    v_smfmac_f32_16x16x64_bf16 v[88:91], v[80:83], v[112:119], v72
    ds_read_b64_tr_b16 v[150:151], v15 offset:4608
    v_smfmac_f32_16x16x64_bf16 v[76:79], v[80:83], v[120:127], v72
    ds_read_b64_tr_b16 v[152:153], v15 offset:12288
    v_mfma_f32_16x16x32_bf16 v[24:27], v[116:119], v[96:99], v[24:27]
    ds_read_b64_tr_b16 v[154:155], v15 offset:12800
    v_mfma_f32_16x16x32_bf16 v[28:31], v[116:119], v[100:103], v[28:31]
    ds_read_b64_tr_b16 v[156:157], v15 offset:20480
    v_mfma_f32_16x16x32_bf16 v[32:35], v[116:119], v[104:107], v[32:35]
    ds_read_b64_tr_b16 v[158:159], v15 offset:20992
    v_mfma_f32_16x16x32_bf16 v[36:39], v[116:119], v[108:111], v[36:39]
    ds_read_b128 v[128:131], v9 offset:0
    v_mfma_f32_16x16x32_bf16 v[40:43], v[96:99], v[120:123], v[40:43]
    ds_read_b128 v[132:135], v9 offset:2048
    v_mfma_f32_16x16x32_bf16 v[56:59], v[96:99], v[124:127], v[56:59]
    ds_read_b128 v[136:139], v9 offset:4096
    v_mfma_f32_16x16x32_bf16 v[60:63], v[100:103], v[124:127], v[60:63]
    ds_read_b128 v[140:143], v9 offset:6144
    v_mfma_f32_16x16x32_bf16 v[44:47], v[100:103], v[120:123], v[44:47]
    ds_read_b128 v[144:147], v13 offset:0
    v_mfma_f32_16x16x32_bf16 v[48:51], v[104:107], v[120:123], v[48:51]
    v_mfma_f32_16x16x32_bf16 v[64:67], v[104:107], v[124:127], v[64:67]
    v_mfma_f32_16x16x32_bf16 v[68:71], v[108:111], v[124:127], v[68:71]
    v_mfma_f32_16x16x32_bf16 v[52:55], v[108:111], v[120:123], v[52:55]
    s_waitcnt vmcnt(2)
    s_waitcnt lgkmcnt(0)
    s_barrier
    buffer_load_dword v221, v220, s[24:27], s84 offen
    s_add_u32 s84, s84, 524288
    v_mfma_f32_16x16x32_bf16 v[84:87], v[144:147], v[144:147], v[84:87]
    ds_read_b64_tr_b16 v[116:117], v15 offset:32768
    v_smfmac_f32_16x16x64_bf16 v[88:91], v[80:83], v[144:151], v72
    ds_read_b64_tr_b16 v[118:119], v15 offset:33280
    v_smfmac_f32_16x16x64_bf16 v[76:79], v[80:83], v[152:159], v72
    ds_read_b64_tr_b16 v[120:121], v15 offset:40960
    v_mfma_f32_16x16x32_bf16 v[24:27], v[148:151], v[128:131], v[24:27]
    ds_read_b64_tr_b16 v[122:123], v15 offset:41472
    v_mfma_f32_16x16x32_bf16 v[28:31], v[148:151], v[132:135], v[28:31]
    ds_read_b64_tr_b16 v[124:125], v15 offset:49152
    v_mfma_f32_16x16x32_bf16 v[32:35], v[148:151], v[136:139], v[32:35]
    ds_read_b64_tr_b16 v[126:127], v15 offset:49664
    v_mfma_f32_16x16x32_bf16 v[36:39], v[148:151], v[140:143], v[36:39]
    ds_read_b128 v[96:99], v8 offset:32768
    v_mfma_f32_16x16x32_bf16 v[40:43], v[128:131], v[152:155], v[40:43]
    ds_read_b128 v[100:103], v8 offset:34816
    v_mfma_f32_16x16x32_bf16 v[56:59], v[128:131], v[156:159], v[56:59]
    ds_read_b128 v[104:107], v8 offset:36864
    v_mfma_f32_16x16x32_bf16 v[60:63], v[132:135], v[156:159], v[60:63]
    ds_read_b128 v[108:111], v8 offset:38912
    v_mfma_f32_16x16x32_bf16 v[44:47], v[132:135], v[152:155], v[44:47]
    ds_read_b128 v[112:115], v12 offset:32768
    v_mfma_f32_16x16x32_bf16 v[48:51], v[136:139], v[152:155], v[48:51]
    v_mfma_f32_16x16x32_bf16 v[64:67], v[136:139], v[156:159], v[64:67]
    v_mfma_f32_16x16x32_bf16 v[68:71], v[140:143], v[156:159], v[68:71]
    v_mfma_f32_16x16x32_bf16 v[52:55], v[140:143], v[152:155], v[52:55]
    s_waitcnt lgkmcnt(0)
    v_mfma_f32_16x16x32_bf16 v[84:87], v[112:115], v[112:115], v[84:87]
    ds_read_b64_tr_b16 v[148:149], v15 offset:36864
    v_smfmac_f32_16x16x64_bf16 v[88:91], v[80:83], v[112:119], v72
    ds_read_b64_tr_b16 v[150:151], v15 offset:37376
    v_smfmac_f32_16x16x64_bf16 v[76:79], v[80:83], v[120:127], v72
    ds_read_b64_tr_b16 v[152:153], v15 offset:45056
    v_mfma_f32_16x16x32_bf16 v[24:27], v[116:119], v[96:99], v[24:27]
    ds_read_b64_tr_b16 v[154:155], v15 offset:45568
    v_mfma_f32_16x16x32_bf16 v[28:31], v[116:119], v[100:103], v[28:31]
    ds_read_b64_tr_b16 v[156:157], v15 offset:53248
    v_mfma_f32_16x16x32_bf16 v[32:35], v[116:119], v[104:107], v[32:35]
    ds_read_b64_tr_b16 v[158:159], v15 offset:53760
    v_mfma_f32_16x16x32_bf16 v[36:39], v[116:119], v[108:111], v[36:39]
    ds_read_b128 v[128:131], v9 offset:32768
    v_mfma_f32_16x16x32_bf16 v[40:43], v[96:99], v[120:123], v[40:43]
    ds_read_b128 v[132:135], v9 offset:34816
    v_mfma_f32_16x16x32_bf16 v[56:59], v[96:99], v[124:127], v[56:59]
    ds_read_b128 v[136:139], v9 offset:36864
    v_mfma_f32_16x16x32_bf16 v[60:63], v[100:103], v[124:127], v[60:63]
    ds_read_b128 v[140:143], v9 offset:38912
    v_mfma_f32_16x16x32_bf16 v[44:47], v[100:103], v[120:123], v[44:47]
    ds_read_b128 v[144:147], v13 offset:32768
    v_mfma_f32_16x16x32_bf16 v[48:51], v[104:107], v[120:123], v[48:51]
    v_mfma_f32_16x16x32_bf16 v[64:67], v[104:107], v[124:127], v[64:67]
    v_mfma_f32_16x16x32_bf16 v[68:71], v[108:111], v[124:127], v[68:71]
    v_mfma_f32_16x16x32_bf16 v[52:55], v[108:111], v[120:123], v[52:55]
    s_waitcnt lgkmcnt(0)
    s_barrier
    buffer_load_dword v221, v220, s[24:27], s84 offen
    s_add_u32 s84, s84, 524288
    v_mfma_f32_16x16x32_bf16 v[84:87], v[144:147], v[144:147], v[84:87]
    v_smfmac_f32_16x16x64_bf16 v[88:91], v[80:83], v[144:151], v72
    v_smfmac_f32_16x16x64_bf16 v[76:79], v[80:83], v[152:159], v72
    v_mfma_f32_16x16x32_bf16 v[24:27], v[148:151], v[128:131], v[24:27]
    v_mfma_f32_16x16x32_bf16 v[28:31], v[148:151], v[132:135], v[28:31]
    v_mfma_f32_16x16x32_bf16 v[32:35], v[148:151], v[136:139], v[32:35]
    v_mfma_f32_16x16x32_bf16 v[36:39], v[148:151], v[140:143], v[36:39]
    v_mfma_f32_16x16x32_bf16 v[40:43], v[128:131], v[152:155], v[40:43]
    v_mfma_f32_16x16x32_bf16 v[56:59], v[128:131], v[156:159], v[56:59]
    v_mfma_f32_16x16x32_bf16 v[60:63], v[132:135], v[156:159], v[60:63]
    v_mfma_f32_16x16x32_bf16 v[44:47], v[132:135], v[152:155], v[44:47]
    v_mfma_f32_16x16x32_bf16 v[48:51], v[136:139], v[152:155], v[48:51]
    v_mfma_f32_16x16x32_bf16 v[64:67], v[136:139], v[156:159], v[64:67]
    v_mfma_f32_16x16x32_bf16 v[68:71], v[140:143], v[156:159], v[68:71]
    v_mfma_f32_16x16x32_bf16 v[52:55], v[140:143], v[152:155], v[52:55]
    s_mov_b32 s4, 0xaaaaaaaa
    s_mov_b32 s5, 0xaaaaaaaa
    s_mov_b32 s6, 0xcccccccc
    s_mov_b32 s7, 0xcccccccc
    v_and_b32 v16, 15, v0
    v_lshlrev_b32 v16, 2, v16
    v_add_u32 v16, 139264, v16
    v_lshl_add_u32 v17, s3, 6, v16
    v_and_b32 v18, 48, v0
    v_add_u32 v19, 139264, v18
    v_cndmask_b32 v98, v84, v85, s[4:5]
    v_cndmask_b32 v99, v86, v87, s[4:5]
    v_cndmask_b32 v96, v98, v99, s[6:7]
    v_add_f32 v97, v88, v89
    v_add_f32 v98, v90, v91
    v_add_f32 v80, v78, v79
    v_add_f32 v81, v78, v79
    v_add_f32 v76, v76, v77
    v_mov_b32 v77, v76
    v_lshl_add_u32 v100, s3, 6, v19
    v_mul_f32 v97, 0xbb000000, v97
    v_mul_f32 v96, 0x3b000000, v96
    v_fma_f32 v96, -v97, v97, v96
    v_max_f32 v96, 0, v96
    v_add_f32 v96, 0x3727c5ac, v96
    v_rsq_f32 v96, v96
    s_mov_b32 exec_lo, 0x00f0000f
    s_mov_b32 exec_hi, 0xf0000f00
    ds_write_b32 v17, v97
    ds_write_b32 v17, v98 offset:512
    ds_write_b32 v17, v96 offset:256
    s_mov_b64 exec, -1
    s_waitcnt lgkmcnt(0)
    s_barrier
    ds_read_b128 v[108:111], v19 offset:0
    ds_read_b128 v[124:127], v19 offset:256
    ds_read_b128 v[112:115], v19 offset:64
    ds_read_b128 v[128:131], v19 offset:320
    ds_read_b128 v[116:119], v19 offset:128
    ds_read_b128 v[132:135], v19 offset:384
    ds_read_b128 v[120:123], v19 offset:192
    ds_read_b128 v[136:139], v19 offset:448
    ds_read_b128 v[72:75], v100 offset:512
    ds_read2_b32 v[88:89], v16 offset0:0 offset1:64
    ds_read2_b32 v[90:91], v16 offset0:16 offset1:80
    ds_read2_b32 v[92:93], v16 offset0:32 offset1:96
    ds_read2_b32 v[94:95], v16 offset0:48 offset1:112
    s_mov_b32 s86, 0x358637bd
    s_mov_b32 s87, 0x3fb8aa3b
    s_lshl_b32 s6, s45, 2
    s_add_u32 s6, s6, s3
    s_lshl_b32 s6, s6, 5
    s_add_u32 s6, s6, s44
    s_lshl_b32 s88, s6, 10
    s_add_u32 s88, s88, 8388608
    s_lshl_b32 s89, s6, 6
    s_add_u32 s89, s89, 9437184
    s_waitcnt lgkmcnt(11)
    v_pk_fma_f32 v[40:41], v[108:109], v[76:77], v[40:41]
    v_pk_fma_f32 v[42:43], v[110:111], v[76:77], v[42:43]
    v_pk_fma_f32 v[56:57], v[108:109], v[80:81], v[56:57]
    v_pk_fma_f32 v[58:59], v[110:111], v[80:81], v[58:59]
    v_pk_fma_f32 v[40:41], v[40:41], v[124:125], s[86:87] op_sel_hi:[1,1,0]
    v_pk_fma_f32 v[42:43], v[42:43], v[126:127], s[86:87] op_sel_hi:[1,1,0]
    v_pk_mul_f32 v[56:57], v[56:57], v[124:125]
    v_pk_mul_f32 v[58:59], v[58:59], v[126:127]
    v_cvt_pk_bf16_f32 v156, v56, v57
    v_cvt_pk_bf16_f32 v157, v58, v59
    v_pk_mul_f32 v[140:141], v[40:41], s[86:87] op_sel:[0,1] op_sel_hi:[1,1]
    v_pk_mul_f32 v[142:143], v[42:43], s[86:87] op_sel:[0,1] op_sel_hi:[1,1]
    v_exp_f32_e64 v140, v140 clamp
    v_exp_f32_e64 v141, v141 clamp
    v_exp_f32_e64 v142, v142 clamp
    v_exp_f32_e64 v143, v143 clamp
    v_max_f32 v40, s86, v40
    v_max_f32 v41, s86, v41
    v_max_f32 v42, s86, v42
    v_max_f32 v43, s86, v43
    v_pk_add_f32 v[40:41], v[40:41], v[140:141]
    v_pk_add_f32 v[42:43], v[42:43], v[142:143]
    v_cvt_pk_bf16_f32 v148, v40, v41
    v_cvt_pk_bf16_f32 v149, v42, v43
    s_waitcnt lgkmcnt(9)
    v_pk_fma_f32 v[44:45], v[112:113], v[76:77], v[44:45]
    v_pk_fma_f32 v[46:47], v[114:115], v[76:77], v[46:47]
    v_pk_fma_f32 v[60:61], v[112:113], v[80:81], v[60:61]
    v_pk_fma_f32 v[62:63], v[114:115], v[80:81], v[62:63]
    v_pk_fma_f32 v[44:45], v[44:45], v[128:129], s[86:87] op_sel_hi:[1,1,0]
    v_pk_fma_f32 v[46:47], v[46:47], v[130:131], s[86:87] op_sel_hi:[1,1,0]
    v_pk_mul_f32 v[60:61], v[60:61], v[128:129]
    v_pk_mul_f32 v[62:63], v[62:63], v[130:131]
    v_cvt_pk_bf16_f32 v158, v60, v61
    v_cvt_pk_bf16_f32 v159, v62, v63
    v_pk_mul_f32 v[140:141], v[44:45], s[86:87] op_sel:[0,1] op_sel_hi:[1,1]
    v_pk_mul_f32 v[142:143], v[46:47], s[86:87] op_sel:[0,1] op_sel_hi:[1,1]
    v_exp_f32_e64 v140, v140 clamp
    v_exp_f32_e64 v141, v141 clamp
    v_exp_f32_e64 v142, v142 clamp
    v_exp_f32_e64 v143, v143 clamp
    v_max_f32 v44, s86, v44
    v_max_f32 v45, s86, v45
    v_max_f32 v46, s86, v46
    v_max_f32 v47, s86, v47
    v_pk_add_f32 v[44:45], v[44:45], v[140:141]
    v_pk_add_f32 v[46:47], v[46:47], v[142:143]
    v_cvt_pk_bf16_f32 v150, v44, v45
    v_cvt_pk_bf16_f32 v151, v46, v47
    s_waitcnt lgkmcnt(7)
    v_pk_fma_f32 v[48:49], v[116:117], v[76:77], v[48:49]
    v_pk_fma_f32 v[50:51], v[118:119], v[76:77], v[50:51]
    v_pk_fma_f32 v[64:65], v[116:117], v[80:81], v[64:65]
    v_pk_fma_f32 v[66:67], v[118:119], v[80:81], v[66:67]
    v_pk_fma_f32 v[48:49], v[48:49], v[132:133], s[86:87] op_sel_hi:[1,1,0]
    v_pk_fma_f32 v[50:51], v[50:51], v[134:135], s[86:87] op_sel_hi:[1,1,0]
    v_pk_mul_f32 v[64:65], v[64:65], v[132:133]
    v_pk_mul_f32 v[66:67], v[66:67], v[134:135]
    v_cvt_pk_bf16_f32 v160, v64, v65
    v_cvt_pk_bf16_f32 v161, v66, v67
    v_pk_mul_f32 v[140:141], v[48:49], s[86:87] op_sel:[0,1] op_sel_hi:[1,1]
    v_pk_mul_f32 v[142:143], v[50:51], s[86:87] op_sel:[0,1] op_sel_hi:[1,1]
    v_exp_f32_e64 v140, v140 clamp
    v_exp_f32_e64 v141, v141 clamp
    v_exp_f32_e64 v142, v142 clamp
    v_exp_f32_e64 v143, v143 clamp
    v_max_f32 v48, s86, v48
    v_max_f32 v49, s86, v49
    v_max_f32 v50, s86, v50
    v_max_f32 v51, s86, v51
    v_pk_add_f32 v[48:49], v[48:49], v[140:141]
    v_pk_add_f32 v[50:51], v[50:51], v[142:143]
    v_cvt_pk_bf16_f32 v152, v48, v49
    v_cvt_pk_bf16_f32 v153, v50, v51
    s_waitcnt lgkmcnt(5)
    v_pk_fma_f32 v[52:53], v[120:121], v[76:77], v[52:53]
    v_pk_fma_f32 v[54:55], v[122:123], v[76:77], v[54:55]
    v_pk_fma_f32 v[68:69], v[120:121], v[80:81], v[68:69]
    v_pk_fma_f32 v[70:71], v[122:123], v[80:81], v[70:71]
    v_pk_fma_f32 v[52:53], v[52:53], v[136:137], s[86:87] op_sel_hi:[1,1,0]
    v_pk_fma_f32 v[54:55], v[54:55], v[138:139], s[86:87] op_sel_hi:[1,1,0]
    v_pk_mul_f32 v[68:69], v[68:69], v[136:137]
    v_pk_mul_f32 v[70:71], v[70:71], v[138:139]
    v_cvt_pk_bf16_f32 v162, v68, v69
    v_cvt_pk_bf16_f32 v163, v70, v71
    v_pk_mul_f32 v[140:141], v[52:53], s[86:87] op_sel:[0,1] op_sel_hi:[1,1]
    v_pk_mul_f32 v[142:143], v[54:55], s[86:87] op_sel:[0,1] op_sel_hi:[1,1]
    v_exp_f32_e64 v140, v140 clamp
    v_exp_f32_e64 v141, v141 clamp
    v_exp_f32_e64 v142, v142 clamp
    v_exp_f32_e64 v143, v143 clamp
    v_max_f32 v52, s86, v52
    v_max_f32 v53, s86, v53
    v_max_f32 v54, s86, v54
    v_max_f32 v55, s86, v55
    v_pk_add_f32 v[52:53], v[52:53], v[140:141]
    v_pk_add_f32 v[54:55], v[54:55], v[142:143]
    v_cvt_pk_bf16_f32 v154, v52, v53
    v_cvt_pk_bf16_f32 v155, v54, v55
    s_waitcnt lgkmcnt(0)
    v_pk_fma_f32 v[24:25], v[88:89], v[72:73], v[24:25] op_sel_hi:[0,1,1]
    v_pk_fma_f32 v[26:27], v[88:89], v[74:75], v[26:27] op_sel_hi:[0,1,1]
    v_mfma_f32_16x16x32_bf16 v[172:175], v[148:151], v[156:159], 0
    v_mfma_f32_16x16x32_bf16 v[176:179], v[148:151], v[20:23], 0
    v_mfma_f32_16x16x32_bf16 v[172:175], v[152:155], v[160:163], v[172:175]
    v_mfma_f32_16x16x32_bf16 v[176:179], v[152:155], v[20:23], v[176:179]
    v_pk_fma_f32 v[24:25], v[24:25], v[88:89], s[86:87] op_sel:[0,1,0] op_sel_hi:[1,1,0]
    v_pk_fma_f32 v[26:27], v[26:27], v[88:89], s[86:87] op_sel:[0,1,0] op_sel_hi:[1,1,0]
    s_nop 4
    buffer_store_dwordx4 v[172:175], v1, s[28:31], s88 offen sc1
    s_mov_b32 exec_lo, 0x00010001
    s_mov_b32 exec_hi, 0x00010001
    buffer_store_dwordx4 v[176:179], v18, s[28:31], s89 offen sc1
    s_mov_b64 exec, -1
    buffer_load_dword v221, v220, s[24:27], s84 offen
    s_add_u32 s84, s84, 524288
    v_pk_fma_f32 v[28:29], v[90:91], v[72:73], v[28:29] op_sel_hi:[0,1,1]
    v_pk_fma_f32 v[30:31], v[90:91], v[74:75], v[30:31] op_sel_hi:[0,1,1]
    v_pk_fma_f32 v[28:29], v[28:29], v[90:91], s[86:87] op_sel:[0,1,0] op_sel_hi:[1,1,0]
    v_pk_fma_f32 v[30:31], v[30:31], v[90:91], s[86:87] op_sel:[0,1,0] op_sel_hi:[1,1,0]
    v_pk_fma_f32 v[32:33], v[92:93], v[72:73], v[32:33] op_sel_hi:[0,1,1]
    v_pk_fma_f32 v[34:35], v[92:93], v[74:75], v[34:35] op_sel_hi:[0,1,1]
    v_pk_fma_f32 v[32:33], v[32:33], v[92:93], s[86:87] op_sel:[0,1,0] op_sel_hi:[1,1,0]
    v_pk_fma_f32 v[34:35], v[34:35], v[92:93], s[86:87] op_sel:[0,1,0] op_sel_hi:[1,1,0]
    v_pk_fma_f32 v[36:37], v[94:95], v[72:73], v[36:37] op_sel_hi:[0,1,1]
    v_pk_fma_f32 v[38:39], v[94:95], v[74:75], v[38:39] op_sel_hi:[0,1,1]
    v_pk_fma_f32 v[36:37], v[36:37], v[94:95], s[86:87] op_sel:[0,1,0] op_sel_hi:[1,1,0]
    v_pk_fma_f32 v[38:39], v[38:39], v[94:95], s[86:87] op_sel:[0,1,0] op_sel_hi:[1,1,0]
    v_pk_mul_f32 v[140:141], v[24:25], s[86:87] op_sel:[0,1] op_sel_hi:[1,1]
    v_pk_mul_f32 v[142:143], v[26:27], s[86:87] op_sel:[0,1] op_sel_hi:[1,1]
    v_exp_f32_e64 v140, v140 clamp
    v_exp_f32_e64 v141, v141 clamp
    v_exp_f32_e64 v142, v142 clamp
    v_exp_f32_e64 v143, v143 clamp
    v_max_f32 v24, s86, v24
    v_max_f32 v25, s86, v25
    v_max_f32 v26, s86, v26
    v_max_f32 v27, s86, v27
    v_pk_add_f32 v[24:25], v[24:25], v[140:141]
    v_pk_add_f32 v[26:27], v[26:27], v[142:143]
    v_cvt_pk_bf16_f32 v184, v24, v25
    v_cvt_pk_bf16_f32 v185, v26, v27
    v_pk_mul_f32 v[140:141], v[28:29], s[86:87] op_sel:[0,1] op_sel_hi:[1,1]
    v_pk_mul_f32 v[142:143], v[30:31], s[86:87] op_sel:[0,1] op_sel_hi:[1,1]
    v_exp_f32_e64 v140, v140 clamp
    v_exp_f32_e64 v141, v141 clamp
    v_exp_f32_e64 v142, v142 clamp
    v_exp_f32_e64 v143, v143 clamp
    v_max_f32 v28, s86, v28
    v_max_f32 v29, s86, v29
    v_max_f32 v30, s86, v30
    v_max_f32 v31, s86, v31
    v_pk_add_f32 v[28:29], v[28:29], v[140:141]
    v_pk_add_f32 v[30:31], v[30:31], v[142:143]
    v_cvt_pk_bf16_f32 v186, v28, v29
    v_cvt_pk_bf16_f32 v187, v30, v31
    v_pk_mul_f32 v[140:141], v[32:33], s[86:87] op_sel:[0,1] op_sel_hi:[1,1]
    v_pk_mul_f32 v[142:143], v[34:35], s[86:87] op_sel:[0,1] op_sel_hi:[1,1]
    v_permlane16_swap_b32 v184, v186
    v_permlane16_swap_b32 v185, v187
    v_exp_f32_e64 v140, v140 clamp
    v_exp_f32_e64 v141, v141 clamp
    v_exp_f32_e64 v142, v142 clamp
    v_exp_f32_e64 v143, v143 clamp
    v_max_f32 v32, s86, v32
    v_max_f32 v33, s86, v33
    v_max_f32 v34, s86, v34
    v_max_f32 v35, s86, v35
    v_pk_add_f32 v[32:33], v[32:33], v[140:141]
    v_pk_add_f32 v[34:35], v[34:35], v[142:143]
    v_cvt_pk_bf16_f32 v188, v32, v33
    v_cvt_pk_bf16_f32 v189, v34, v35
    v_pk_mul_f32 v[140:141], v[36:37], s[86:87] op_sel:[0,1] op_sel_hi:[1,1]
    v_pk_mul_f32 v[142:143], v[38:39], s[86:87] op_sel:[0,1] op_sel_hi:[1,1]
    v_exp_f32_e64 v140, v140 clamp
    v_exp_f32_e64 v141, v141 clamp
    v_exp_f32_e64 v142, v142 clamp
    v_exp_f32_e64 v143, v143 clamp
    v_max_f32 v36, s86, v36
    v_max_f32 v37, s86, v37
    v_max_f32 v38, s86, v38
    v_max_f32 v39, s86, v39
    v_pk_add_f32 v[36:37], v[36:37], v[140:141]
    v_pk_add_f32 v[38:39], v[38:39], v[142:143]
    v_cvt_pk_bf16_f32 v190, v36, v37
    v_cvt_pk_bf16_f32 v191, v38, v39
    s_nop 0
    v_permlane16_swap_b32 v188, v190
    v_permlane16_swap_b32 v189, v191
    s_lshl_b32 s4, s65, 2
    s_add_u32 s4, s4, s66
L_w7:
    s_cbranch_execz L_wret
    s_sub_u32 s67, s4, 28
    s_lshl_b32 s82, s45, 5
    s_add_u32 s82, s82, s44
    s_waitcnt vmcnt(1)
    s_barrier
    s_cmp_lg_u32 s3, 0
    s_cbranch_scc1 L_sigh2
    s_lshl_b32 s4, s82, 7
    s_add_u32 s4, s4, 10485760
    s_mov_b64 exec, 0xff
    buffer_store_dwordx4 v[180:183], v253, s[28:31], s4 offen sc1
    s_mov_b64 exec, -1
L_sigh2:
    v_and_b32 v16, 31, v0
    v_lshlrev_b32 v16, 7, v16
    s_lshl_b32 s4, s67, 14
    s_add_u32 s4, s4, s78
    buffer_load_dword v221, v16, s[16:19], s4 offen
    buffer_load_dword v221, v220, s[24:27], s84 offen
    s_add_u32 s84, s84, 524288
    s_waitcnt vmcnt(1)
    buffer_load_dword v221, v220, s[24:27], s84 offen
    s_add_u32 s84, s84, 524288
    s_waitcnt vmcnt(1)
    s_bfe_u32 s76, s56, 0x40000
    s_mul_i32 s74, s76, 524288
    s_add_u32 m0, s78, 0
    s_add_u32 s74, s74, s60
    buffer_load_dwordx4 v200, s[24:27], s74 offen lds
    buffer_load_dwordx4 v201, s[24:27], s74 offen offset:1024 lds
    buffer_load_dwordx4 v202, s[24:27], s74 offen offset:2048 lds
    v_min_u32 v19, 31, v0
    v_lshlrev_b32 v19, 7, v19
    s_lshl_b32 s4, s65, 12
    s_add_u32 s81, s4, 10485760
    s_cmp_lg_u32 s3, 1
    s_cbranch_scc1 L_pih3
    buffer_load_dword v252, v19, s[28:31], s81 offen sc1
L_pih3:
    s_cmp_lg_u32 s3, 1
    s_cbranch_scc1 L_okh4
    s_waitcnt vmcnt(0)
    v_cmp_ne_u32 vcc, s64, v252
    s_cbranch_vccz L_okh4
    s_mov_b32 s79, 100000
L_okh4s:
    buffer_load_dword v252, v19, s[28:31], s81 offen sc1
    s_waitcnt vmcnt(0)
    v_cmp_ne_u32 vcc, s64, v252
    s_cbranch_vccz L_okh4
    s_sub_u32 s79, s79, 1
    s_cmp_lg_u32 s79, 0
    s_cbranch_scc1 L_okh4s
L_okh4:
    s_barrier
    s_lshl_b32 s4, s67, 5
    s_lshl_b32 s5, s3, 3
    s_add_u32 s4, s4, s5
    s_lshl_b32 s5, s4, 10
    s_add_u32 s5, s5, 8388608
    s_add_u32 s6, s5, 4096
    s_lshl_b32 s7, s4, 6
    s_add_u32 s7, s7, 9437184
    v_and_b32 v16, 0x1ff, v1
    buffer_load_dwordx4 v[56:59], v16, s[28:31], s7 offen sc1
    buffer_load_dwordx4 v[24:27], v1, s[28:31], s5 offen offset:0 sc1
    buffer_load_dwordx4 v[28:31], v1, s[28:31], s5 offen offset:1024 sc1
    buffer_load_dwordx4 v[32:35], v1, s[28:31], s5 offen offset:2048 sc1
    buffer_load_dwordx4 v[36:39], v1, s[28:31], s5 offen offset:3072 sc1
    buffer_load_dwordx4 v[40:43], v1, s[28:31], s6 offen offset:0 sc1
    buffer_load_dwordx4 v[44:47], v1, s[28:31], s6 offen offset:1024 sc1
    buffer_load_dwordx4 v[48:51], v1, s[28:31], s6 offen offset:2048 sc1
    buffer_load_dwordx4 v[52:55], v1, s[28:31], s6 offen offset:3072 sc1
    v_add_u32 v17, 131072, v1
    v_add_u32 v16, s77, v17
    v_and_b32 v18, 48, v0
    v_add_u32 v18, 132288, v18
    buffer_load_dwordx4 v203, s[24:27], s74 offen offset:3072 lds
    s_bfe_u32 s76, s56, 0x40004
    s_mul_i32 s74, s76, 524288
    s_add_u32 m0, s78, 16384
    s_add_u32 s74, s74, s60
    buffer_load_dwordx4 v200, s[24:27], s74 offen lds
    buffer_load_dwordx4 v201, s[24:27], s74 offen offset:1024 lds
    buffer_load_dwordx4 v202, s[24:27], s74 offen offset:2048 lds
    s_lshl_b32 s5, s67, 10
    s_add_u32 s5, s5, 4194304
    s_waitcnt vmcnt(12)
    v_add_f32_dpp v56, v56, v56 row_shr:4 row_mask:0xf bank_mask:0xf bound_ctrl:1
    v_add_f32_dpp v57, v57, v57 row_shr:4 row_mask:0xf bank_mask:0xf bound_ctrl:1
    v_add_f32_dpp v58, v58, v58 row_shr:4 row_mask:0xf bank_mask:0xf bound_ctrl:1
    v_add_f32_dpp v59, v59, v59 row_shr:4 row_mask:0xf bank_mask:0xf bound_ctrl:1
    v_add_f32_dpp v56, v56, v56 row_shr:8 row_mask:0xf bank_mask:0xf bound_ctrl:1
    v_add_f32_dpp v57, v57, v57 row_shr:8 row_mask:0xf bank_mask:0xf bound_ctrl:1
    v_add_f32_dpp v58, v58, v58 row_shr:8 row_mask:0xf bank_mask:0xf bound_ctrl:1
    v_add_f32_dpp v59, v59, v59 row_shr:8 row_mask:0xf bank_mask:0xf bound_ctrl:1
    ds_write_b128 v16, v[56:59] offset:1024
    s_waitcnt vmcnt(10)
    v_pk_add_f32 v[24:25], v[24:25], v[28:29]
    v_pk_add_f32 v[26:27], v[26:27], v[30:31]
    s_waitcnt vmcnt(9)
    v_pk_add_f32 v[24:25], v[24:25], v[32:33]
    v_pk_add_f32 v[26:27], v[26:27], v[34:35]
    s_waitcnt vmcnt(8)
    v_pk_add_f32 v[24:25], v[24:25], v[36:37]
    v_pk_add_f32 v[26:27], v[26:27], v[38:39]
    s_waitcnt vmcnt(7)
    v_pk_add_f32 v[24:25], v[24:25], v[40:41]
    v_pk_add_f32 v[26:27], v[26:27], v[42:43]
    s_waitcnt vmcnt(6)
    v_pk_add_f32 v[24:25], v[24:25], v[44:45]
    v_pk_add_f32 v[26:27], v[26:27], v[46:47]
    s_waitcnt vmcnt(5)
    v_pk_add_f32 v[24:25], v[24:25], v[48:49]
    v_pk_add_f32 v[26:27], v[26:27], v[50:51]
    s_waitcnt vmcnt(4)
    v_pk_add_f32 v[24:25], v[24:25], v[52:53]
    v_pk_add_f32 v[26:27], v[26:27], v[54:55]
    ds_write_b128 v16, v[24:27]
    buffer_load_dwordx4 v203, s[24:27], s74 offen offset:3072 lds
    s_bfe_u32 s76, s56, 0x40008
    s_mul_i32 s74, s76, 524288
    s_add_u32 m0, s78, 32768
    s_add_u32 s74, s74, s60
    buffer_load_dwordx4 v200, s[24:27], s74 offen lds
    buffer_load_dwordx4 v201, s[24:27], s74 offen offset:1024 lds
    buffer_load_dwordx4 v202, s[24:27], s74 offen offset:2048 lds
    s_waitcnt lgkmcnt(0)
    s_barrier
    ds_read_b128 v[24:27], v17 offset:0
    ds_read_b128 v[56:59], v18 offset:0
    ds_read_b128 v[60:63], v18 offset:256
    ds_read_b128 v[28:31], v17 offset:2048
    ds_read_b128 v[64:67], v18 offset:2048
    ds_read_b128 v[68:71], v18 offset:2304
    ds_read_b128 v[32:35], v17 offset:4096
    ds_read_b128 v[72:75], v18 offset:4096
    ds_read_b128 v[76:79], v18 offset:4352
    ds_read_b128 v[36:39], v17 offset:6144
    ds_read_b128 v[80:83], v18 offset:6144
    ds_read_b128 v[84:87], v18 offset:6400
    s_waitcnt lgkmcnt(0)
    v_pk_add_f32 v[24:25], v[24:25], v[28:29]
    v_pk_add_f32 v[56:57], v[56:57], v[60:61]
    v_pk_add_f32 v[26:27], v[26:27], v[30:31]
    v_pk_add_f32 v[58:59], v[58:59], v[62:63]
    v_pk_add_f32 v[24:25], v[24:25], v[32:33]
    v_pk_add_f32 v[56:57], v[56:57], v[64:65]
    v_pk_add_f32 v[26:27], v[26:27], v[34:35]
    v_pk_add_f32 v[58:59], v[58:59], v[66:67]
    v_pk_add_f32 v[24:25], v[24:25], v[36:37]
    v_pk_add_f32 v[56:57], v[56:57], v[68:69]
    v_pk_add_f32 v[26:27], v[26:27], v[38:39]
    v_pk_add_f32 v[58:59], v[58:59], v[70:71]
    v_pk_add_f32 v[56:57], v[56:57], v[72:73]
    v_pk_add_f32 v[58:59], v[58:59], v[74:75]
    v_pk_add_f32 v[56:57], v[56:57], v[76:77]
    v_pk_add_f32 v[58:59], v[58:59], v[78:79]
    v_pk_add_f32 v[56:57], v[56:57], v[80:81]
    v_pk_add_f32 v[58:59], v[58:59], v[82:83]
    v_pk_add_f32 v[56:57], v[56:57], v[84:85]
    v_pk_add_f32 v[58:59], v[58:59], v[86:87]
    v_cvt_pk_bf16_f32 v92, v24, v25
    v_cvt_pk_bf16_f32 v93, v26, v27
    v_cvt_pk_bf16_f32 v94, v56, v57
    v_cvt_pk_bf16_f32 v95, v58, v59
    s_nop 0
    v_permlane16_swap_b32 v92, v94
    v_permlane16_swap_b32 v93, v95
    s_cmp_lg_u32 s3, 0
    s_cbranch_scc1 L_kvzh5
    buffer_store_dwordx4 v[92:95], v1, s[28:31], s5 offen sc1
L_kvzh5:
    buffer_load_dwordx4 v203, s[24:27], s74 offen offset:3072 lds
    s_bfe_u32 s76, s56, 0x4000c
    s_mul_i32 s74, s76, 524288
    s_add_u32 m0, s78, 49152
    s_add_u32 s74, s74, s60
    buffer_load_dwordx4 v200, s[24:27], s74 offen lds
    buffer_load_dwordx4 v201, s[24:27], s74 offen offset:1024 lds
    buffer_load_dwordx4 v202, s[24:27], s74 offen offset:2048 lds
    buffer_load_dwordx4 v203, s[24:27], s74 offen offset:3072 lds
    s_bfe_u32 s76, s56, 0x40010
    s_mul_i32 s74, s76, 524288
    s_add_u32 m0, s78, 65536
    s_add_u32 s74, s74, s60
    buffer_load_dwordx4 v200, s[24:27], s74 offen lds
    buffer_load_dwordx4 v201, s[24:27], s74 offen offset:1024 lds
    buffer_load_dwordx4 v202, s[24:27], s74 offen offset:2048 lds
    s_cmp_lg_u32 s3, 0
    s_cbranch_scc1 L_kvwh6
    s_waitcnt vmcnt(8)
L_kvwh6:
    s_cmp_lg_u32 s3, 0
    s_cbranch_scc1 L_sigh7
    s_lshl_b32 s4, s67, 7
    s_add_u32 s4, s4, 10747904
    buffer_store_dwordx4 v[180:183], v253, s[28:31], s4 offen sc1
L_sigh7:
    s_barrier
    v_add_u32 v204, 0x10000, v212
    v_add_u32 v205, 0x10000, v213
    v_add_u32 v206, 0x10000, v214
    v_add_u32 v207, 0x10000, v215
    buffer_load_dwordx4 v203, s[24:27], s74 offen offset:3072 lds
    s_add_u32 m0, s77, 131072
    s_nop 0
    buffer_load_dwordx4 v4, s[8:11], s50 offen lds
    buffer_load_dwordx4 v5, s[8:11], s50 offen offset:1024 lds
    s_waitcnt vmcnt(14)
    s_barrier
    ds_read_b64_tr_b16 a[32:33], v212 offset:0
    ds_read_b64_tr_b16 a[34:35], v212 offset:2048
    ds_read_b64_tr_b16 a[36:37], v213 offset:0
    ds_read_b64_tr_b16 a[38:39], v213 offset:2048
    s_bfe_u32 s76, s56, 0x40014
    s_mul_i32 s74, s76, 524288
    s_add_u32 m0, s78, 81920
    s_add_u32 s74, s74, s60
    buffer_load_dwordx4 v200, s[24:27], s74 offen lds
    ds_read_b64_tr_b16 a[40:41], v214 offset:0
    ds_read_b64_tr_b16 a[42:43], v214 offset:2048
    ds_read_b64_tr_b16 a[44:45], v215 offset:0
    ds_read_b64_tr_b16 a[46:47], v215 offset:2048
    buffer_load_dwordx4 v201, s[24:27], s74 offen offset:1024 lds
    ds_read_b64_tr_b16 a[48:49], v212 offset:4096
    ds_read_b64_tr_b16 a[50:51], v212 offset:6144
    ds_read_b64_tr_b16 a[52:53], v213 offset:4096
    ds_read_b64_tr_b16 a[54:55], v213 offset:6144
    buffer_load_dwordx4 v202, s[24:27], s74 offen offset:2048 lds
    ds_read_b64_tr_b16 a[56:57], v214 offset:4096
    ds_read_b64_tr_b16 a[58:59], v214 offset:6144
    ds_read_b64_tr_b16 a[60:61], v215 offset:4096
    ds_read_b64_tr_b16 a[62:63], v215 offset:6144
    buffer_load_dwordx4 v203, s[24:27], s74 offen offset:3072 lds
    ds_read_b64_tr_b16 a[96:97], v212 offset:16384
    ds_read_b64_tr_b16 a[98:99], v212 offset:18432
    ds_read_b64_tr_b16 a[100:101], v213 offset:16384
    ds_read_b64_tr_b16 a[102:103], v213 offset:18432
    s_bfe_u32 s76, s56, 0x40018
    s_mul_i32 s74, s76, 524288
    s_add_u32 m0, s78, 98304
    s_add_u32 s74, s74, s60
    buffer_load_dwordx4 v200, s[24:27], s74 offen lds
    ds_read_b64_tr_b16 a[104:105], v214 offset:16384
    ds_read_b64_tr_b16 a[106:107], v214 offset:18432
    ds_read_b64_tr_b16 a[108:109], v215 offset:16384
    ds_read_b64_tr_b16 a[110:111], v215 offset:18432
    buffer_load_dwordx4 v201, s[24:27], s74 offen offset:1024 lds
    ds_read_b64_tr_b16 a[112:113], v212 offset:20480
    ds_read_b64_tr_b16 a[114:115], v212 offset:22528
    ds_read_b64_tr_b16 a[116:117], v213 offset:20480
    ds_read_b64_tr_b16 a[118:119], v213 offset:22528
    buffer_load_dwordx4 v202, s[24:27], s74 offen offset:2048 lds
    ds_read_b64_tr_b16 a[120:121], v214 offset:20480
    ds_read_b64_tr_b16 a[122:123], v214 offset:22528
    ds_read_b64_tr_b16 a[124:125], v215 offset:20480
    ds_read_b64_tr_b16 a[126:127], v215 offset:22528
    buffer_load_dwordx4 v203, s[24:27], s74 offen offset:3072 lds
    s_waitcnt vmcnt(14)
    s_waitcnt lgkmcnt(0)
    s_barrier
    ds_read_b64_tr_b16 a[128:129], v212 offset:32768
    ds_read_b64_tr_b16 a[130:131], v212 offset:34816
    ds_read_b64_tr_b16 a[132:133], v213 offset:32768
    ds_read_b64_tr_b16 a[134:135], v213 offset:34816
    s_bfe_u32 s76, s56, 0x4001c
    s_mul_i32 s74, s76, 524288
    s_add_u32 m0, s78, 114688
    s_add_u32 s74, s74, s60
    buffer_load_dwordx4 v200, s[24:27], s74 offen lds
    ds_read_b64_tr_b16 a[136:137], v214 offset:32768
    ds_read_b64_tr_b16 a[138:139], v214 offset:34816
    ds_read_b64_tr_b16 a[140:141], v215 offset:32768
    ds_read_b64_tr_b16 a[142:143], v215 offset:34816
    buffer_load_dwordx4 v201, s[24:27], s74 offen offset:1024 lds
    ds_read_b64_tr_b16 a[144:145], v212 offset:36864
    ds_read_b64_tr_b16 a[146:147], v212 offset:38912
    ds_read_b64_tr_b16 a[148:149], v213 offset:36864
    ds_read_b64_tr_b16 a[150:151], v213 offset:38912
    buffer_load_dwordx4 v202, s[24:27], s74 offen offset:2048 lds
    ds_read_b64_tr_b16 a[152:153], v214 offset:36864
    ds_read_b64_tr_b16 a[154:155], v214 offset:38912
    ds_read_b64_tr_b16 a[156:157], v215 offset:36864
    ds_read_b64_tr_b16 a[158:159], v215 offset:38912
    buffer_load_dwordx4 v203, s[24:27], s74 offen offset:3072 lds
    ds_read_b64_tr_b16 a[160:161], v212 offset:49152
    ds_read_b64_tr_b16 a[162:163], v212 offset:51200
    ds_read_b64_tr_b16 a[164:165], v213 offset:49152
    ds_read_b64_tr_b16 a[166:167], v213 offset:51200
    s_bfe_u32 s76, s57, 0x40000
    s_mul_i32 s74, s76, 524288
    s_add_u32 m0, s78, 0
    s_add_u32 s74, s74, s60
    buffer_load_dwordx4 v200, s[24:27], s74 offen lds
    ds_read_b64_tr_b16 a[168:169], v214 offset:49152
    ds_read_b64_tr_b16 a[170:171], v214 offset:51200
    ds_read_b64_tr_b16 a[172:173], v215 offset:49152
    ds_read_b64_tr_b16 a[174:175], v215 offset:51200
    buffer_load_dwordx4 v201, s[24:27], s74 offen offset:1024 lds
    ds_read_b64_tr_b16 a[176:177], v212 offset:53248
    ds_read_b64_tr_b16 a[178:179], v212 offset:55296
    ds_read_b64_tr_b16 a[180:181], v213 offset:53248
    ds_read_b64_tr_b16 a[182:183], v213 offset:55296
    buffer_load_dwordx4 v202, s[24:27], s74 offen offset:2048 lds
    ds_read_b64_tr_b16 a[184:185], v214 offset:53248
    ds_read_b64_tr_b16 a[186:187], v214 offset:55296
    ds_read_b64_tr_b16 a[188:189], v215 offset:53248
    ds_read_b64_tr_b16 a[190:191], v215 offset:55296
    buffer_load_dwordx4 v203, s[24:27], s74 offen offset:3072 lds
    s_waitcnt vmcnt(12)
    s_waitcnt lgkmcnt(0)
    s_barrier
    ds_read_b64_tr_b16 a[192:193], v204 offset:0
    ds_read_b64_tr_b16 a[194:195], v204 offset:2048
    ds_read_b64_tr_b16 a[196:197], v205 offset:0
    ds_read_b64_tr_b16 a[198:199], v205 offset:2048
    s_bfe_u32 s76, s57, 0x40004
    s_mul_i32 s74, s76, 524288
    s_add_u32 m0, s78, 16384
    s_add_u32 s74, s74, s60
    buffer_load_dwordx4 v200, s[24:27], s74 offen lds
    ds_read_b64_tr_b16 a[200:201], v206 offset:0
    ds_read_b64_tr_b16 a[202:203], v206 offset:2048
    ds_read_b64_tr_b16 a[204:205], v207 offset:0
    ds_read_b64_tr_b16 a[206:207], v207 offset:2048
    buffer_load_dwordx4 v201, s[24:27], s74 offen offset:1024 lds
    ds_read_b64_tr_b16 a[208:209], v204 offset:4096
    ds_read_b64_tr_b16 a[210:211], v204 offset:6144
    ds_read_b64_tr_b16 a[212:213], v205 offset:4096
    ds_read_b64_tr_b16 a[214:215], v205 offset:6144
    buffer_load_dwordx4 v202, s[24:27], s74 offen offset:2048 lds
    ds_read_b64_tr_b16 a[216:217], v206 offset:4096
    ds_read_b64_tr_b16 a[218:219], v206 offset:6144
    ds_read_b64_tr_b16 a[220:221], v207 offset:4096
    ds_read_b64_tr_b16 a[222:223], v207 offset:6144
    buffer_load_dwordx4 v203, s[24:27], s74 offen offset:3072 lds
    ds_read_b64_tr_b16 a[224:225], v204 offset:16384
    ds_read_b64_tr_b16 a[226:227], v204 offset:18432
    ds_read_b64_tr_b16 a[228:229], v205 offset:16384
    ds_read_b64_tr_b16 a[230:231], v205 offset:18432
    s_bfe_u32 s76, s57, 0x40008
    s_mul_i32 s74, s76, 524288
    s_add_u32 m0, s78, 32768
    s_add_u32 s74, s74, s60
    buffer_load_dwordx4 v200, s[24:27], s74 offen lds
    ds_read_b64_tr_b16 a[232:233], v206 offset:16384
    ds_read_b64_tr_b16 a[234:235], v206 offset:18432
    ds_read_b64_tr_b16 a[236:237], v207 offset:16384
    ds_read_b64_tr_b16 a[238:239], v207 offset:18432
    buffer_load_dwordx4 v201, s[24:27], s74 offen offset:1024 lds
    ds_read_b64_tr_b16 a[240:241], v204 offset:20480
    ds_read_b64_tr_b16 a[242:243], v204 offset:22528
    ds_read_b64_tr_b16 a[244:245], v205 offset:20480
    ds_read_b64_tr_b16 a[246:247], v205 offset:22528
    buffer_load_dwordx4 v202, s[24:27], s74 offen offset:2048 lds
    ds_read_b64_tr_b16 a[248:249], v206 offset:20480
    ds_read_b64_tr_b16 a[250:251], v206 offset:22528
    ds_read_b64_tr_b16 a[252:253], v207 offset:20480
    ds_read_b64_tr_b16 a[254:255], v207 offset:22528
    buffer_load_dwordx4 v203, s[24:27], s74 offen offset:3072 lds
    v_and_b32 v16, 31, v0
    v_lshl_add_u32 v16, s46, 5, v16
    v_bfe_u32 v17, v16, 1, 3
    s_lshl_b32 s4, s47, 2
    v_xor_b32 v17, s4, v17
    v_lshlrev_b32 v17, 4, v17
    v_lshl_add_u32 v17, v16, 7, v17
    v_lshrrev_b32 v16, 5, v0
    v_lshlrev_b32 v16, 4, v16
    s_bfe_u32 s76, s57, 0x4000c
    s_mul_i32 s74, s76, 524288
    s_add_u32 m0, s78, 49152
    s_add_u32 s74, s74, s60
    buffer_load_dwordx4 v200, s[24:27], s74 offen lds
    v_xor_b32 v17, v16, v17
    v_add_u32 v218, 131072, v17
    v_xor_b32 v17, 32, v218
    ds_read_b128 v[88:91], v218
    ds_read_b128 v[92:95], v17
    s_add_u32 s4, s77, 131072
    v_lshlrev_b32 v56, 16, v254
    v_mov_b32 v64, v56
    v_add_u32 v18, s4, v1
    s_nop 0
    v_permlane16_swap_b32 v56, v64
    v_mov_b32 v57, v56
    buffer_load_dwordx4 v201, s[24:27], s74 offen offset:1024 lds
    v_mov_b32 v58, v56
    v_mov_b32 v59, v56
    v_mov_b32 v60, v56
    v_mov_b32 v61, v56
    v_mov_b32 v62, v56
    v_mov_b32 v63, v56
    v_mov_b32 v65, v64
    v_mov_b32 v66, v64
    buffer_load_dwordx4 v202, s[24:27], s74 offen offset:2048 lds
    v_mov_b32 v67, v64
    v_mov_b32 v68, v64
    v_mov_b32 v69, v64
    v_mov_b32 v70, v64
    v_mov_b32 v71, v64
    s_waitcnt lgkmcnt(0)
    v_lshlrev_b32 v128, 16, v88
    v_and_b32 v129, 0xffff0000, v88
    v_lshlrev_b32 v130, 16, v89
    buffer_load_dwordx4 v203, s[24:27], s74 offen offset:3072 lds
    v_and_b32 v131, 0xffff0000, v89
    v_lshlrev_b32 v132, 16, v90
    v_and_b32 v133, 0xffff0000, v90
    v_lshlrev_b32 v134, 16, v91
    v_and_b32 v135, 0xffff0000, v91
    v_lshlrev_b32 v136, 16, v92
    v_and_b32 v137, 0xffff0000, v92
    v_lshlrev_b32 v138, 16, v93
    v_and_b32 v139, 0xffff0000, v93
    v_lshlrev_b32 v140, 16, v94
    v_and_b32 v141, 0xffff0000, v94
    v_lshlrev_b32 v142, 16, v95
    v_and_b32 v143, 0xffff0000, v95
    s_waitcnt vmcnt(16)
    s_branch L_common
L_end:
    s_endpgm

.section .rodata,"a"
.p2align 6
.amdhsa_kernel recurrent_scan__linear_attn_block__mixer_token_mlp__prompt_kernel
  .amdhsa_next_free_vgpr 512
  .amdhsa_next_free_sgpr 102
  .amdhsa_accum_offset 256
  .amdhsa_group_segment_fixed_size 0
  .amdhsa_kernarg_size 88
  .amdhsa_user_sgpr_count 2
  .amdhsa_user_sgpr_kernarg_segment_ptr 1
  .amdhsa_system_sgpr_workgroup_id_x 1
.end_amdhsa_kernel
```
